```python
import torch

def _softmax(x, axis=-1):
    return torch.softmax(x, dim=axis)
def _gelu(x):
    return torch.nn.functional.gelu(x, approximate="tanh")
def _silu(x):
    return torch.nn.functional.silu(x)
def _sigmoid(x):
    return torch.sigmoid(x)
def _layernorm(x, axis=-1, eps=1e-5):
    m = x.mean(dim=axis, keepdim=True)
    v = x.var(dim=axis, keepdim=True, unbiased=False)
    return (x - m) / torch.sqrt(v + eps)
def _scatter_add(tgt, idx, src, axis=0):
    return tgt.clone().index_add_(axis, idx, src)
def _segment_sum(src, seg, n):
    out = torch.zeros((n,) + src.shape[1:], dtype=src.dtype)
    return out.index_add_(0, seg, src)
def _pad(x, pw):
    flat = tuple(v for pair in reversed(pw) for v in pair)
    return torch.nn.functional.pad(x, flat)

kernel_name = 'parallel_sum__spectral_fnet__moe_arch_mod__prompt'

def setup_inputs():

    _w = (lambda a: (lambda t: t.to(torch.bfloat16) if t.is_floating_point() else t)(torch.as_tensor(a)))
    def _A_setup():
        B, S, D = 1, 2048, 512
        ns = torch.arange(S)[:, None] * torch.arange(S)[None, :]
        nd = torch.arange(D)[:, None] * torch.arange(D)[None, :]
        Ws_re = torch.cos(-2.0 * torch.pi * ns / S).to(float)
        Ws_im = torch.sin(-2.0 * torch.pi * ns / S).to(float)
        Wd_re = torch.cos(-2.0 * torch.pi * nd / D).to(float)
        Wd_im = torch.sin(-2.0 * torch.pi * nd / D).to(float)
        return {
            "x": _w((lambda *s: torch.randn(*s, dtype=torch.bfloat16) * 0.1)(B, S, D)),
            "dft_seq_re": _w(Ws_re),
            "dft_seq_im": _w(Ws_im),
            "dft_hid_re": _w(Wd_re),
            "dft_hid_im": _w(Wd_im),
        }
    _A_in = _A_setup()

    def _B_setup():
        B, S, D, F, C = 1, 2048, 512, 1792, 8
        return {
            "x": _w((lambda *s: torch.randn(*s, dtype=torch.bfloat16) * 0.1)(B, S, D)),
            "w_r": _w((lambda *s: torch.randn(*s, dtype=torch.bfloat16) * 0.4)(D)),
            "w_gate": _w((lambda *s: torch.randn(*s, dtype=torch.bfloat16) * 0.4)(D, F)),
            "w_up": _w((lambda *s: torch.randn(*s, dtype=torch.bfloat16) * 0.4)(D, F)),
            "w_down": _w((lambda *s: torch.randn(*s, dtype=torch.bfloat16) * 0.4)(F, D)),
        }
    _B_in = _B_setup()

    return {
        "A_x": _A_in["x"],
        "A_dft_seq_re": _A_in["dft_seq_re"],
        "A_dft_seq_im": _A_in["dft_seq_im"],
        "A_dft_hid_re": _A_in["dft_hid_re"],
        "A_dft_hid_im": _A_in["dft_hid_im"],
        "B_x": _B_in["x"],
        "B_w_r": _B_in["w_r"],
        "B_w_gate": _B_in["w_gate"],
        "B_w_up": _B_in["w_up"],
        "B_w_down": _B_in["w_down"],
    }

def reference(A_x, A_dft_seq_re, A_dft_seq_im, A_dft_hid_re, A_dft_hid_im, B_x, B_w_r, B_w_gate, B_w_up, B_w_down):
    def _A_ref(x, dft_seq_re, dft_seq_im, dft_hid_re, dft_hid_im):
        a = torch.einsum("bsd,ed->bse", x, dft_hid_re)
        b = torch.einsum("bsd,ed->bse", x, dft_hid_im)
        y = torch.einsum("ts,bse->bte", dft_seq_re, a) - torch.einsum("ts,bse->bte", dft_seq_im, b)
        return y

    def _B_ref(x, w_r, w_gate, w_up, w_down):
        B, S, D = x.shape
        C = 8
        r = x @ w_r
        idx = torch.argsort(-r, axis=-1)[:, :C]
        idx_e = (lambda x, n, axis: torch.repeat_interleave(x, n, dim=axis))(idx.reshape(B, C, 1), D, axis=2)
        x_sel = (lambda x, i, axis: torch.take_along_dim(x, i, dim=axis))(x, idx_e, axis=1)
        g = _silu(x_sel @ w_gate)
        u = x_sel @ w_up
        y = (g * u) @ w_down
        r_sel = _sigmoid((lambda x, i, axis: torch.take_along_dim(x, i, dim=axis))(r, idx, axis=1))
        y = y * r_sel.reshape(B, C, 1)
        b_off = (torch.arange(B) * S).reshape(B, 1)
        flat_idx = (idx + b_off).reshape(B * C)
        zero = (x * 0.0).reshape(B * S, D)
        upd = _scatter_add(zero, flat_idx, y.reshape(B * C, D), axis=0)
        return x + upd.reshape(B, S, D)

    x = A_x
    xn = _layernorm(x, axis=-1)
    return x + _A_ref(xn, A_dft_seq_re, A_dft_seq_im, A_dft_hid_re, A_dft_hid_im) + _B_ref(xn, B_w_r, B_w_gate, B_w_up, B_w_down)
```

```asm
; @launch grid=(256,1,1) block=(512,1,1) lds=79872
.amdgcn_target "amdgcn-amd-amdhsa--gfx950"
.text
.globl parallel_sum__spectral_fnet__moe_arch_mod__prompt_kernel
.p2align 8
.type parallel_sum__spectral_fnet__moe_arch_mod__prompt_kernel,@function
parallel_sum__spectral_fnet__moe_arch_mod__prompt_kernel:
s_cmp_ge_u32 s2, 128
s_cbranch_scc1 L_pro2
s_load_dwordx2 s[8:9], s[0:1], 0
s_load_dwordx2 s[20:21], s[0:1], 48
v_lshrrev_b32 v4, 6, v0
v_and_b32 v1, 63, v0
v_readfirstlane_b32 s3, v4
v_lshrrev_b32 v2, 4, v1
v_and_b32 v3, 15, v1
s_and_b32 s82, s2, 7
s_mov_b32 s10, 2097152
s_mov_b32 s11, 0x20000
s_sub_u32 s48, 16, s82
s_cmp_eq_u32 s82, 0
s_cselect_b32 s48, 8, s48
s_bitcmp1_b32 s2, 3
s_cselect_b32 s39, s48, s82
s_and_b32 s101, s2, 0x70
s_add_u32 s101, s101, s39
s_lshl_b32 s48, s3, 7
s_add_u32 s48, s48, s101
s_lshl_b32 s48, s48, 10
s_add_u32 s49, s48, 0x100000
v_lshlrev_b32 v4, 8, v2
v_lshl_add_u32 v4, v3, 2, v4
s_waitcnt lgkmcnt(0)
buffer_load_dword v8, v4, s[8:11], s48 offen offset:0
buffer_load_dword v9, v4, s[8:11], s48 offen offset:64
buffer_load_dword v10, v4, s[8:11], s48 offen offset:128
buffer_load_dword v11, v4, s[8:11], s48 offen offset:192
buffer_load_dword v12, v4, s[8:11], s49 offen offset:0
buffer_load_dword v13, v4, s[8:11], s49 offen offset:64
buffer_load_dword v14, v4, s[8:11], s49 offen offset:128
buffer_load_dword v15, v4, s[8:11], s49 offen offset:192
s_load_dwordx2 s[12:13], s[0:1], 96
s_mov_b32 s22, 1024
s_mov_b32 s23, 0x20000
buffer_load_dword v16, v4, s[20:23], 0 offen offset:0
buffer_load_dword v17, v4, s[20:23], 0 offen offset:64
buffer_load_dword v18, v4, s[20:23], 0 offen offset:128
buffer_load_dword v19, v4, s[20:23], 0 offen offset:192
s_branch L_p1b
L_pro2:
s_cmp_ge_u32 s2, 256
s_cbranch_scc1 L_end
s_cmp_lt_u32 s2, 192
s_cbranch_scc1 L_nocode
s_getpc_b64 s[48:49]
L_pc:
s_sub_u32 s48, s48, L_pc-parallel_sum__spectral_fnet__moe_arch_mod__prompt_kernel
s_subb_u32 s49, s49, 0
v_lshlrev_b32 v4, 4, v0
v_add_u32 v5, 8192, v4
v_min_u32 v5, L_code_end-parallel_sum__spectral_fnet__moe_arch_mod__prompt_kernel-16, v5
global_load_dwordx4 v[24:27], v4, s[48:49]
global_load_dwordx4 v[28:31], v5, s[48:49]
L_nocode:
s_load_dwordx2 s[12:13], s[0:1], 96
s_load_dwordx2 s[8:9], s[0:1], 0
s_load_dwordx2 s[24:25], s[0:1], 56
s_load_dwordx2 s[28:29], s[0:1], 64
s_load_dwordx2 s[32:33], s[0:1], 72
v_lshrrev_b32 v4, 6, v0
v_and_b32 v1, 63, v0
v_readfirstlane_b32 s3, v4
v_lshrrev_b32 v2, 4, v1
v_and_b32 v3, 15, v1
s_and_b32 s82, s2, 7
s_mov_b32 s14, 16777216
s_mov_b32 s15, 0x20000
s_mov_b32 s10, 2097152
s_mov_b32 s11, 0x20000
s_mov_b32 s26, 1835008
s_mov_b32 s27, 0x20000
s_mov_b32 s30, 1835008
s_mov_b32 s31, 0x20000
s_mov_b32 s34, 1835008
s_mov_b32 s35, 0x20000
s_mov_b32 s45, 0x3f803f80
s_mov_b32 s46, 0xffff0000
s_branch L_notp1
L_p1b:
s_mov_b32 s14, 16777216
s_mov_b32 s15, 0x20000
s_setprio 3
s_cmp_lg_u32 s3, 7
s_cbranch_scc1 L_nonon
s_waitcnt lgkmcnt(0)
buffer_load_dword v20, off, s[12:15], 0 offset:0 sc1
L_nonon:
s_load_dwordx2 s[24:25], s[0:1], 56
s_load_dwordx2 s[28:29], s[0:1], 64
s_load_dwordx2 s[16:17], s[0:1], 80
s_mov_b32 s26, 1835008
s_mov_b32 s27, 0x20000
s_mov_b32 s30, 1835008
s_mov_b32 s31, 0x20000
s_mov_b32 s18, 2097152
s_mov_b32 s19, 0x20000
s_mov_b32 s45, 0x3f803f80
s_mov_b32 s46, 0xffff0000
v_cvt_f32_u32 v80, v3
v_cvt_f32_u32 v81, v2
s_cmp_eq_u32 s3, 1
s_cbranch_scc1 L_cg1
s_cmp_eq_u32 s3, 2
s_cbranch_scc1 L_cg2
s_cmp_eq_u32 s3, 3
s_cbranch_scc1 L_cg3
s_cmp_eq_u32 s3, 4
s_cbranch_scc1 L_cg4
s_cmp_eq_u32 s3, 5
s_cbranch_scc1 L_cg5
s_cmp_eq_u32 s3, 6
s_cbranch_scc1 L_cg6
s_cmp_lg_u32 s3, 7
s_cbranch_scc1 L_cgen
s_branch L_cg7
L_cgw:
s_lshl_b32 s50, s3, 11
v_lshl_add_u32 v94, v1, 4, s50
ds_write_b128 v94, v[96:99] offset:29184
ds_write_b128 v94, v[100:103] offset:30208
L_cg7:
v_lshrrev_b32 v125, 5, v1
s_lshl_b32 s50, s3, 2
v_lshl_add_u32 v124, v125, 1, s50
v_lshl_add_u32 v125, v125, 5, s50
s_lshl_b32 s44, s101, 7
s_add_u32 s43, s44, 524288
s_add_u32 s44, s44, 65536
v_and_b32 v120, 7, v1
v_lshrrev_b32 v122, 3, v1
v_lshlrev_b32 v122, 14, v122
v_lshl_add_u32 v122, v120, 3, v122
v_lshlrev_b32 v120, 2, v120
v_and_b32 v121, 1, v3
v_lshlrev_b32 v121, 4, v121
v_add_u32 v121, v121, v3
v_lshlrev_b32 v121, 1, v121
v_and_b32 v121, 60, v121
v_lshlrev_b32 v123, 3, v3
v_lshlrev_b32 v6, 4, v1
s_lshr_b32 s76, s2, 4
s_sub_u32 s50, 16, s39
s_and_b32 s50, s50, 15
s_sub_u32 s51, 15, s76
s_lshr_b32 s40, s3, 2
s_and_b32 s77, s3, 3
s_cmp_lg_u32 s40, 0
s_cselect_b32 s37, s50, s39
s_cselect_b32 s38, s51, s76
s_mov_b32 s47, 65537
v_lshlrev_b32 v104, 4, v3
v_lshl_add_u32 v104, v2, 2, v104
v_bfe_u32 v105, v104, 5, 2
v_lshlrev_b32 v105, 2, v105
v_xor_b32 v21, v104, v105
v_lshlrev_b32 v21, 2, v21
s_mul_i32 s50, s3, 2080
s_add_u32 s50, s50, 12288
v_add_u32 v21, s50, v21
s_mov_b32 s51, 4160
s_lshl_b32 s52, s3, 5
s_add_u32 s53, s52, 16
v_add_u32 v104, s52, v3
v_sub_u32 v106, 512, v104
v_and_b32 v106, 511, v106
v_bfe_u32 v105, v104, 5, 2
v_lshlrev_b32 v105, 2, v105
v_xor_b32 v4, v104, v105
v_lshlrev_b32 v4, 2, v4
v_bfe_u32 v105, v106, 5, 2
v_lshlrev_b32 v105, 2, v105
v_xor_b32 v5, v106, v105
v_lshlrev_b32 v5, 2, v5
v_mad_u32_u24 v4, v2, s51, v4
v_mad_u32_u24 v5, v2, s51, v5
v_add_u32 v104, s53, v3
v_sub_u32 v106, 512, v104
v_and_b32 v106, 511, v106
v_bfe_u32 v105, v104, 5, 2
v_lshlrev_b32 v105, 2, v105
v_xor_b32 v22, v104, v105
v_lshlrev_b32 v22, 2, v22
v_bfe_u32 v105, v106, 5, 2
v_lshlrev_b32 v105, 2, v105
v_xor_b32 v23, v106, v105
v_lshlrev_b32 v23, 2, v23
v_mad_u32_u24 v22, v2, s51, v22
v_mad_u32_u24 v23, v2, s51, v23
s_lshl_b32 s55, s101, 10
s_lshl_b32 s52, s3, 7
s_add_u32 s54, s55, s52
s_add_u32 s54, s54, 1048576
s_sub_u32 s52, s52, 128
s_and_b32 s52, s52, 0x380
s_add_u32 s55, s55, s52
s_add_u32 s55, s55, 262144
v_and_b32 v104, 7, v3
v_and_b32 v105, 8, v3
v_lshlrev_b32 v7, 4, v2
v_lshl_add_u32 v7, v104, 17, v7
v_lshl_add_u32 v7, v105, 3, v7
s_add_u32 s53, s54, 1048576
s_mov_b32 s66, 0x00ff00ff
s_mov_b32 s67, 0x00ff00ff
s_lshl_b32 s48, s77, 8
s_add_u32 s48, s48, s39
v_lshl_add_u32 v119, v3, 4, s48
v_sub_u32 v104, 2048, v119
v_and_b32 v104, 2047, v104
s_cmp_lg_u32 s40, 0
s_cselect_b64 vcc, -1, 0
v_cndmask_b32 v104, v119, v104, vcc
v_lshlrev_b32 v112, 10, v104
v_lshl_add_u32 v112, v2, 4, v112
s_lshl_b32 s7, s38, 6
s_mov_b32 s83, 65536
v_and_b32 v113, 127, v104
v_bfe_u32 v104, v104, 7, 3
v_lshlrev_b32 v113, 7, v113
v_lshl_add_u32 v113, v104, 4, v113
s_waitcnt lgkmcnt(0)
s_and_b32 s56, s2, 0x78
s_add_u32 s56, s56, s3
v_lshrrev_b32 v100, 3, v1
v_mul_u32_u24 v100, 3584, v100
v_and_b32 v101, 7, v1
v_lshl_add_u32 v100, v101, 4, v100
v_lshlrev_b32 v101, 4, v1
s_and_b32 s57, s56, 3
s_lshl_b32 s57, s57, 3
s_add_u32 s57, s57, s82
s_lshr_b32 s56, s56, 2
s_cmp_ge_u32 s57, 28
s_cbranch_scc1 L_nopf_1
s_mov_b32 m0, 11264
s_mul_i32 s58, s56, 28672
s_lshl_b32 s59, s57, 7
s_add_u32 s58, s58, s59
s_lshl_b32 s59, s57, 6
s_add_u32 s59, s59, s56
s_lshl_b32 s59, s59, 10
s_mov_b32 s60, 0
L_pfl_2:
buffer_load_dwordx4 v100, s[24:27], s58 offen lds
buffer_load_dwordx4 v100, s[28:31], s58 offen lds
s_add_u32 s58, s58, 917504
s_add_u32 s60, s60, 1
s_cmp_lt_u32 s60, 2
s_cbranch_scc1 L_pfl_2
L_nopf_1:
s_cmp_ge_u32 s57, 28
s_cbranch_scc1 L_w0
s_waitcnt vmcnt(4)
s_branch L_w1
L_w0:
s_waitcnt vmcnt(0)
L_w1:
v_dot2_f32_bf16 v80, v8, s45, 0
v_dot2_f32_bf16 v83, v12, s45, 0
v_dot2_f32_bf16 v81, v8, v8, 0
v_dot2_f32_bf16 v84, v12, v12, 0
v_dot2_f32_bf16 v82, v8, v16, 0
v_dot2_f32_bf16 v85, v12, v16, 0
v_dot2_f32_bf16 v86, v16, s45, 0
v_dot2_f32_bf16 v80, v9, s45, v80
v_dot2_f32_bf16 v83, v13, s45, v83
v_dot2_f32_bf16 v81, v9, v9, v81
v_dot2_f32_bf16 v84, v13, v13, v84
v_dot2_f32_bf16 v82, v9, v17, v82
v_dot2_f32_bf16 v85, v13, v17, v85
v_dot2_f32_bf16 v86, v17, s45, v86
v_dot2_f32_bf16 v80, v10, s45, v80
v_dot2_f32_bf16 v83, v14, s45, v83
v_dot2_f32_bf16 v81, v10, v10, v81
v_dot2_f32_bf16 v84, v14, v14, v84
v_dot2_f32_bf16 v82, v10, v18, v82
v_dot2_f32_bf16 v85, v14, v18, v85
v_dot2_f32_bf16 v86, v18, s45, v86
v_dot2_f32_bf16 v80, v11, s45, v80
v_dot2_f32_bf16 v83, v15, s45, v83
v_dot2_f32_bf16 v81, v11, v11, v81
v_dot2_f32_bf16 v84, v15, v15, v84
v_dot2_f32_bf16 v82, v11, v19, v82
v_dot2_f32_bf16 v85, v15, v19, v85
v_dot2_f32_bf16 v86, v19, s45, v86
s_cmp_lg_u32 s3, 7
s_cbranch_scc1 L_notag
v_readfirstlane_b32 s36, v20
s_mul_i32 s36, s36, 0x9E3779B1
s_add_u32 s36, s36, 0x7F4A7C15
v_mov_b32 v95, s36
v_mov_b32 v94, 0
ds_write_b32 v94, v95 offset:548
L_notag:
s_nop 0
v_mov_b32 v87, v86
v_permlane32_swap_b32 v80, v83
v_permlane32_swap_b32 v81, v84
v_permlane32_swap_b32 v82, v85
v_permlane32_swap_b32 v86, v87
v_add_f32 v80, v80, v83
v_add_f32 v81, v81, v84
v_add_f32 v82, v82, v85
v_add_f32 v86, v86, v87
v_permlane16_swap_b32 v80, v81
    s_nop 0
v_permlane16_swap_b32 v82, v86
v_add_f32 v80, v80, v81
v_add_f32 v82, v82, v86
    s_nop 0
v_add_f32_dpp v80, v80, v80 row_ror:8 row_mask:0xf bank_mask:0xf
v_add_f32_dpp v82, v82, v82 row_ror:8 row_mask:0xf bank_mask:0xf
    s_nop 0
v_add_f32_dpp v80, v80, v80 row_ror:4 row_mask:0xf bank_mask:0xf
v_add_f32_dpp v82, v82, v82 row_ror:4 row_mask:0xf bank_mask:0xf
    s_nop 0
v_add_f32_dpp v80, v80, v80 row_ror:2 row_mask:0xf bank_mask:0xf
v_add_f32_dpp v82, v82, v82 row_ror:2 row_mask:0xf bank_mask:0xf
    s_nop 0
v_add_f32_dpp v80, v80, v80 row_ror:1 row_mask:0xf bank_mask:0xf
v_add_f32_dpp v82, v82, v82 row_ror:1 row_mask:0xf bank_mask:0xf
v_mov_b32 v81, v80
v_mov_b32 v86, v82
    s_nop 0
v_permlane16_swap_b32 v80, v81
v_permlane16_swap_b32 v82, v86
v_mul_f32 v83, 0x3b000000, v80
v_mul_f32 v84, 0x3b000000, v81
v_fma_f32 v84, -v83, v83, v84
v_max_f32 v84, 0, v84
v_cvt_pk_bf16_f32 v85, v83, v84
v_and_b32 v84, s46, v85
v_lshlrev_b32 v87, 16, v85
v_add_f32 v84, 0x3727c5ac, v84
v_fma_f32 v82, -v87, v86, v82
v_cvt_pk_bf16_f32 v84, v84, v84
v_and_b32 v84, s46, v84
v_sqrt_f32 v88, v84
    s_nop 0
v_cvt_pk_bf16_f32 v88, v87, v88
v_and_b32 v89, s46, v88
v_rcp_f32 v89, v89
s_mov_b32 exec_lo, 1
v_mul_f32 v90, v89, v82
v_cvt_pk_bf16_f32 v90, v90, v90
s_mov_b32 exec_hi, 1
ds_write_b32 v125, v88 offset:64
v_ashrrev_i32 v91, 31, v90
v_or_b32 v91, 0x80008000, v91
v_xor_b32 v90, v90, v91
ds_write_b16 v124, v90 offset:0
s_mov_b64 exec, -1
s_waitcnt lgkmcnt(0)
s_barrier
s_cmp_lg_u32 s3, 7
s_cbranch_scc1 L_nopub
ds_read_b32 v94, v120 offset:0
ds_read_b32 v92, v121 offset:64
v_mov_b32 v95, s36
v_mov_b32 v93, s36
s_waitcnt lgkmcnt(1)
buffer_store_dwordx2 v[94:95], v122, s[12:15], s43 offen sc1
s_mov_b64 exec, 0xffff
s_waitcnt lgkmcnt(0)
buffer_store_dwordx2 v[92:93], v123, s[12:15], s44 offen sc1
s_mov_b64 exec, -1
L_nopub:
v_mov_b32 v20, 0
ds_read_b32 v20, v20 offset:548
v_mul_f32 v87, -v87, v89
    s_nop 0
v_readlane_b32 s80, v87, 0
v_readlane_b32 s81, v87, 32
v_readlane_b32 s78, v89, 0
v_readlane_b32 s79, v89, 32
ds_read_b128 v[24:27], v6 offset:29184
ds_read_b128 v[28:31], v6 offset:30208
ds_read_b128 v[32:35], v6 offset:31232
ds_read_b128 v[40:43], v6 offset:32256
ds_read_b128 v[36:39], v6 offset:33280
ds_read_b128 v[44:47], v6 offset:34304
v_mov_b32 v88, s80
v_mov_b32 v89, s81
v_lshlrev_b32 v80, 16, v8
v_lshlrev_b32 v81, 16, v12
v_and_b32 v82, s46, v8
v_and_b32 v83, s46, v12
v_lshlrev_b32 v84, 16, v9
v_lshlrev_b32 v85, 16, v13
v_and_b32 v86, s46, v9
v_and_b32 v87, s46, v13
v_fma_f32 v80, v80, s78, v88
v_fma_f32 v81, v81, s79, v89
v_fma_f32 v82, v82, s78, v88
v_fma_f32 v83, v83, s79, v89
v_fma_f32 v84, v84, s78, v88
v_fma_f32 v85, v85, s79, v89
v_fma_f32 v86, v86, s78, v88
v_fma_f32 v87, v87, s79, v89
v_cvt_pk_bf16_f32 v96, v80, v81
v_cvt_pk_bf16_f32 v100, v82, v83
v_cvt_pk_bf16_f32 v97, v84, v85
v_cvt_pk_bf16_f32 v101, v86, v87
ds_read_b128 v[48:51], v6 offset:35328
ds_read_b128 v[52:55], v6 offset:36352
ds_read_b128 v[56:59], v6 offset:37376
ds_read_b128 v[60:63], v6 offset:38400
ds_read_b128 v[64:67], v6 offset:39424
ds_read_b128 v[68:71], v6 offset:40448
v_lshlrev_b32 v80, 16, v10
v_lshlrev_b32 v81, 16, v14
v_and_b32 v82, s46, v10
v_and_b32 v83, s46, v14
v_lshlrev_b32 v84, 16, v11
v_lshlrev_b32 v85, 16, v15
v_and_b32 v86, s46, v11
v_and_b32 v87, s46, v15
v_fma_f32 v80, v80, s78, v88
v_fma_f32 v81, v81, s79, v89
v_fma_f32 v82, v82, s78, v88
v_fma_f32 v83, v83, s79, v89
v_fma_f32 v84, v84, s78, v88
v_fma_f32 v85, v85, s79, v89
v_fma_f32 v86, v86, s78, v88
v_fma_f32 v87, v87, s79, v89
v_cvt_pk_bf16_f32 v98, v80, v81
v_cvt_pk_bf16_f32 v102, v82, v83
v_cvt_pk_bf16_f32 v99, v84, v85
v_cvt_pk_bf16_f32 v103, v86, v87
s_waitcnt lgkmcnt(10)
v_mfma_f32_16x16x32_bf16 v[80:83], v[96:99], v[24:27], 0
v_mfma_f32_16x16x32_bf16 v[84:87], v[96:99], v[28:31], 0
v_mfma_f32_16x16x32_bf16 v[88:91], v[100:103], v[24:27], 0
v_mfma_f32_16x16x32_bf16 v[92:95], v[100:103], v[28:31], 0
ds_read_b128 v[72:75], v6 offset:41472
ds_read_b128 v[76:79], v6 offset:42496
v_readfirstlane_b32 s36, v20
v_xor_b32 v20, 0x100000, v112
buffer_load_dwordx4 v[8:11], v112, s[8:11], s7 offen
buffer_load_dwordx4 v[12:15], v20, s[8:11], s7 offen
v_lshlrev_b32 v19, 2, v2
v_lshrrev_b32 v19, v19, s36
v_mov_b32 v16, v19
v_lshrrev_b32 v17, 1, v19
v_lshrrev_b32 v18, 2, v19
v_lshrrev_b32 v19, 3, v19
s_waitcnt lgkmcnt(10)
v_pk_mul_f32 v[104:105], v[80:81], v[32:33]
v_pk_mul_f32 v[106:107], v[82:83], v[34:35]
v_pk_fma_f32 v[104:105], v[84:85], v[40:41], v[104:105]
v_pk_fma_f32 v[106:107], v[86:87], v[42:43], v[106:107]
v_pk_mul_f32 v[84:85], v[84:85], v[32:33]
v_pk_mul_f32 v[86:87], v[86:87], v[34:35]
v_pk_fma_f32 v[84:85], v[80:81], v[40:41], v[84:85] neg_lo:[1,0,0] neg_hi:[1,0,0]
v_pk_fma_f32 v[86:87], v[82:83], v[42:43], v[86:87] neg_lo:[1,0,0] neg_hi:[1,0,0]
v_cvt_pk_f16_f32 v96, v104, v84
v_cvt_pk_f16_f32 v97, v105, v85
v_cvt_pk_f16_f32 v98, v106, v86
v_cvt_pk_f16_f32 v99, v107, v87
s_waitcnt lgkmcnt(6)
    s_nop 0
v_mfma_f32_16x16x32_f16 v[120:123], v[96:99], v[48:51], 0
v_mfma_f32_16x16x32_f16 v[124:127], v[96:99], v[52:55], 0
s_waitcnt lgkmcnt(8)
v_pk_mul_f32 v[108:109], v[88:89], v[36:37]
v_pk_mul_f32 v[110:111], v[90:91], v[38:39]
v_pk_fma_f32 v[108:109], v[92:93], v[44:45], v[108:109]
v_pk_fma_f32 v[110:111], v[94:95], v[46:47], v[110:111]
v_pk_mul_f32 v[92:93], v[92:93], v[36:37]
v_pk_mul_f32 v[94:95], v[94:95], v[38:39]
v_pk_fma_f32 v[92:93], v[88:89], v[44:45], v[92:93] neg_lo:[1,0,0] neg_hi:[1,0,0]
v_pk_fma_f32 v[94:95], v[90:91], v[46:47], v[94:95] neg_lo:[1,0,0] neg_hi:[1,0,0]
v_cvt_pk_f16_f32 v100, v108, v92
v_cvt_pk_f16_f32 v101, v109, v93
v_cvt_pk_f16_f32 v102, v110, v94
v_cvt_pk_f16_f32 v103, v111, v95
s_waitcnt lgkmcnt(2)
    s_nop 0
v_mfma_f32_16x16x32_f16 v[80:83], v[100:103], v[56:59], v[120:123]
v_mfma_f32_16x16x32_f16 v[84:87], v[100:103], v[60:63], v[124:127]
v_mfma_f32_16x16x32_f16 v[88:91], v[100:103], v[64:67], v[120:123]
v_mfma_f32_16x16x32_f16 v[92:95], v[100:103], v[68:71], v[124:127]
    s_nop 5
v_cvt_pk_f16_f32 v96, v80, v84
v_cvt_pk_f16_f32 v97, v81, v85
v_cvt_pk_f16_f32 v98, v82, v86
v_cvt_pk_f16_f32 v99, v83, v87
ds_write_b128 v21, v[96:99] offset:0
v_cvt_pk_f16_f32 v100, v88, v92
v_cvt_pk_f16_f32 v101, v89, v93
v_cvt_pk_f16_f32 v102, v90, v94
v_cvt_pk_f16_f32 v103, v91, v95
ds_write_b128 v21, v[100:103] offset:1024
v_mov_b32 v121, s36
v_lshlrev_b32 v6, 3, v3
v_mul_u32_u24 v21, 4160, v2
s_waitcnt lgkmcnt(0)
s_barrier
s_cmp_lg_u32 s3, 0
s_cbranch_scc1 L_nox1
ds_read_b32 v24, v21 offset:13312
ds_read_b32 v25, v21 offset:15392
ds_read_b32 v26, v21 offset:13312
ds_read_b32 v27, v21 offset:15392
L_nox1:
ds_read_b32 v80, v4 offset:12288
ds_read_b32 v81, v4 offset:14368
ds_read_b32 v82, v5 offset:12288
ds_read_b32 v83, v5 offset:14368
ds_read_b32 v84, v22 offset:12288
ds_read_b32 v85, v22 offset:14368
ds_read_b32 v86, v23 offset:12288
ds_read_b32 v87, v23 offset:14368
s_waitcnt lgkmcnt(4)
v_mfma_f32_16x16x32_f16 v[88:91], v[80:83], v[72:75], 0
v_mfma_f32_16x16x32_f16 v[92:95], v[80:83], v[76:79], 0
s_waitcnt lgkmcnt(0)
v_mfma_f32_16x16x32_f16 v[96:99], v[84:87], v[72:75], 0
v_mfma_f32_16x16x32_f16 v[100:103], v[84:87], v[76:79], 0
s_cmp_lg_u32 s3, 0
s_cbranch_scc1 L_nox2
v_mfma_f32_16x16x32_f16 v[28:31], v[24:27], v[72:75], 0
v_mfma_f32_16x16x32_f16 v[32:35], v[24:27], v[76:79], 0
L_nox2:
s_nop 2
v_cvt_pk_f16_f32 v104, v88, v92
v_cvt_pk_f16_f32 v105, v89, v93
v_cvt_pk_f16_f32 v106, v90, v94
v_cvt_pk_f16_f32 v107, v91, v95
v_cvt_pk_f16_f32 v108, v96, v100
v_cvt_pk_f16_f32 v109, v97, v101
v_cvt_pk_f16_f32 v110, v98, v102
v_cvt_pk_f16_f32 v111, v99, v103
v_mov_b32 v120, v104
v_mov_b32_dpp v88, v104 row_ror:8 row_mask:0xf bank_mask:0xf
v_mov_b32_dpp v89, v105 row_ror:8 row_mask:0xf bank_mask:0xf
v_mov_b32_dpp v90, v106 row_ror:8 row_mask:0xf bank_mask:0xf
v_mov_b32_dpp v91, v107 row_ror:8 row_mask:0xf bank_mask:0xf
v_mov_b32_dpp v104, v108 row_ror:8 row_mask:0xf bank_mask:0xc
v_mov_b32_dpp v105, v109 row_ror:8 row_mask:0xf bank_mask:0xc
v_mov_b32_dpp v106, v110 row_ror:8 row_mask:0xf bank_mask:0xc
v_mov_b32_dpp v107, v111 row_ror:8 row_mask:0xf bank_mask:0xc
v_bfi_b32 v104, s47, v16, v104
v_bfi_b32 v105, s47, v17, v105
v_bfi_b32 v106, s47, v18, v106
v_bfi_b32 v107, s47, v19, v107
buffer_store_dwordx4 v[104:107], v7, s[12:15], s54 offen sc1
v_cndmask_b32 v108, v108, v88, s[66:67]
v_cndmask_b32 v109, v109, v89, s[66:67]
v_cndmask_b32 v110, v110, v90, s[66:67]
v_cndmask_b32 v111, v111, v91, s[66:67]
v_bfi_b32 v108, s47, v16, v108
v_bfi_b32 v109, s47, v17, v109
v_bfi_b32 v110, s47, v18, v110
v_bfi_b32 v111, s47, v19, v111
buffer_store_dwordx4 v[108:111], v7, s[12:15], s53 offen sc1
s_cmp_lg_u32 s3, 0
s_cbranch_scc1 L_noextra
v_cvt_pk_f16_f32 v120, v28, v32
L_noextra:
s_mov_b64 exec, 0xffff
buffer_store_dwordx2 v[120:121], v6, s[12:15], s55 offen sc1
s_mov_b64 exec, -1
s_setprio 0
s_and_b32 s48, s3, 1
s_lshr_b32 s49, s3, 1
s_lshl_b32 s50, s49, 5
s_add_u32 s50, s50, s48
s_lshl_b32 s51, s39, 7
s_add_u32 s51, s51, s50
s_lshl_b32 s51, s51, 10
s_lshl_b32 s52, s76, 7
s_add_u32 s51, s51, s52
s_add_u32 s4, s51, 1048576
s_lshl_b32 s51, s50, 10
s_add_u32 s51, s51, s52
s_lshl_b32 s52, s39, 3
s_add_u32 s51, s51, s52
s_add_u32 s5, s51, 262144
s_lshl_b32 s51, s48, 2
s_add_u32 s51, s51, s49
s_mul_i32 s51, s51, 2112
s_add_u32 s100, s51, 29184
s_and_b32 s52, s2, 15
s_lshl_b32 s52, s52, 7
s_add_u32 s6, s52, 163840
v_lshrrev_b32 v80, 3, v1
v_and_b32 v81, 7, v1
v_lshlrev_b32 v114, 12, v80
v_lshl_add_u32 v114, v81, 4, v114
buffer_load_dwordx4 v[64:67], v113, s[12:15], s83 offen
v_lshlrev_b32 v5, 11, v1
v_and_b32 v6, 7, v1
v_lshlrev_b32 v6, 3, v6
v_lshl_add_u32 v23, v1, 2, s100
v_mov_b32 v89, s36
v_cvt_f32_u32 v56, v119
v_lshl_add_u32 v57, v2, 3, s40
v_cvt_f32_u32 v57, v57
v_mul_f32 v56, 0x3a000000, v56
v_mul_f32 v57, v57, v56
s_lshl_b32 s48, s3, 12
v_lshl_add_u32 v119, v1, 4, s48
v_mul_f32 v105, 0x42000000, v56
v_mov_b32 v60, v57
v_fmamk_f32 v61, v56, 0x40000000, v57
v_fmamk_f32 v62, v56, 0x40800000, v57
v_fmamk_f32 v63, v56, 0x40c00000, v57
v_cos_f32 v58, v105
v_sin_f32 v104, v105
v_cos_f32 v96, v60
v_sin_f32 v100, v60
v_cos_f32 v97, v61
v_sin_f32 v101, v61
v_cos_f32 v98, v62
v_sin_f32 v102, v62
v_cos_f32 v99, v63
v_sin_f32 v103, v63
v_cvt_pk_f16_f32 v24, v96, v100
v_cvt_pk_f16_f32 v25, v97, v101
v_cvt_pk_f16_f32 v26, v98, v102
v_cvt_pk_f16_f32 v27, v99, v103
v_pk_mul_f32 v[60:61], v[100:101], v[104:105] op_sel_hi:[1,0]
v_pk_mul_f32 v[62:63], v[102:103], v[104:105] op_sel_hi:[1,0]
v_pk_mul_f32 v[100:101], v[100:101], v[58:59] op_sel_hi:[1,0]
v_pk_mul_f32 v[102:103], v[102:103], v[58:59] op_sel_hi:[1,0]
v_pk_fma_f32 v[100:101], v[96:97], v[104:105], v[100:101] op_sel_hi:[1,0,1]
v_pk_fma_f32 v[102:103], v[98:99], v[104:105], v[102:103] op_sel_hi:[1,0,1]
v_pk_fma_f32 v[96:97], v[96:97], v[58:59], v[60:61] op_sel_hi:[1,0,1] neg_lo:[0,0,1] neg_hi:[0,0,1]
v_pk_fma_f32 v[98:99], v[98:99], v[58:59], v[62:63] op_sel_hi:[1,0,1] neg_lo:[0,0,1] neg_hi:[0,0,1]
ds_write_b128 v119, v[24:27] offset:47104
v_cvt_pk_f16_f32 v28, v96, v100
v_cvt_pk_f16_f32 v29, v97, v101
v_cvt_pk_f16_f32 v30, v98, v102
v_cvt_pk_f16_f32 v31, v99, v103
v_pk_mul_f32 v[60:61], v[100:101], v[104:105] op_sel_hi:[1,0]
v_pk_mul_f32 v[62:63], v[102:103], v[104:105] op_sel_hi:[1,0]
v_pk_mul_f32 v[100:101], v[100:101], v[58:59] op_sel_hi:[1,0]
v_pk_mul_f32 v[102:103], v[102:103], v[58:59] op_sel_hi:[1,0]
v_pk_fma_f32 v[100:101], v[96:97], v[104:105], v[100:101] op_sel_hi:[1,0,1]
v_pk_fma_f32 v[102:103], v[98:99], v[104:105], v[102:103] op_sel_hi:[1,0,1]
v_pk_fma_f32 v[96:97], v[96:97], v[58:59], v[60:61] op_sel_hi:[1,0,1] neg_lo:[0,0,1] neg_hi:[0,0,1]
v_pk_fma_f32 v[98:99], v[98:99], v[58:59], v[62:63] op_sel_hi:[1,0,1] neg_lo:[0,0,1] neg_hi:[0,0,1]
ds_write_b128 v119, v[28:31] offset:48128
v_cvt_pk_f16_f32 v32, v96, v100
v_cvt_pk_f16_f32 v33, v97, v101
v_cvt_pk_f16_f32 v34, v98, v102
v_cvt_pk_f16_f32 v35, v99, v103
v_pk_mul_f32 v[60:61], v[100:101], v[104:105] op_sel_hi:[1,0]
v_pk_mul_f32 v[62:63], v[102:103], v[104:105] op_sel_hi:[1,0]
v_pk_mul_f32 v[100:101], v[100:101], v[58:59] op_sel_hi:[1,0]
v_pk_mul_f32 v[102:103], v[102:103], v[58:59] op_sel_hi:[1,0]
v_pk_fma_f32 v[100:101], v[96:97], v[104:105], v[100:101] op_sel_hi:[1,0,1]
v_pk_fma_f32 v[102:103], v[98:99], v[104:105], v[102:103] op_sel_hi:[1,0,1]
v_pk_fma_f32 v[96:97], v[96:97], v[58:59], v[60:61] op_sel_hi:[1,0,1] neg_lo:[0,0,1] neg_hi:[0,0,1]
v_pk_fma_f32 v[98:99], v[98:99], v[58:59], v[62:63] op_sel_hi:[1,0,1] neg_lo:[0,0,1] neg_hi:[0,0,1]
ds_write_b128 v119, v[32:35] offset:49152
v_cvt_pk_f16_f32 v36, v96, v100
v_cvt_pk_f16_f32 v37, v97, v101
v_cvt_pk_f16_f32 v38, v98, v102
v_cvt_pk_f16_f32 v39, v99, v103
ds_write_b128 v119, v[36:39] offset:50176
v_xor_b32 v119, 0x4000, v119
s_mov_b64 exec, 1
s_mov_b32 s74, 0
s_add_u32 s48, s6, 8192
L_poll_g:
buffer_load_dword v4, off, s[12:15], s48 sc1
s_add_u32 s74, s74, 1
s_waitcnt vmcnt(0)
v_cmp_ne_u32 vcc, s36, v4
s_cbranch_vccz L_got_g
s_cmp_lt_u32 s74, 60000
s_cbranch_scc1 L_poll_g
L_got_g:
s_mov_b64 exec, 0xffff
buffer_load_dwordx2 v[88:89], v5, s[12:15], s5 offen sc1
s_mov_b64 exec, -1
buffer_load_dwordx4 v[80:83], v114, s[12:15], s4 offen sc1
buffer_load_dwordx4 v[84:87], v114, s[12:15], s4 offen offset:2048 sc1
v_and_b32 v4, 3, v1
v_lshlrev_b32 v4, 2, v4
v_lshrrev_b32 v4, v4, s36
v_and_b32 v92, s47, v4
v_lshrrev_b32 v93, 1, v4
v_and_b32 v93, s47, v93
v_lshrrev_b32 v94, 2, v4
v_and_b32 v94, s47, v94
v_lshrrev_b32 v95, 3, v4
v_and_b32 v95, s47, v95
v_lshrrev_b32 v56, 3, v1
v_and_b32 v57, 7, v1
v_and_b32 v56, 1, v56
v_lshlrev_b32 v56, 3, v56
v_lshl_add_u32 v56, v2, 9, v56
v_add_u32 v56, s100, v56
v_lshl_add_u32 v115, v57, 4, v56
v_xor_b32 v57, 1, v57
v_lshl_add_u32 v116, v57, 4, v56
s_cmp_lg_u32 s40, 0
s_cselect_b64 vcc, -1, 0
v_lshrrev_b32 v56, 2, v3
v_and_b32 v57, 3, v3
v_lshl_add_u32 v117, v56, 3, v57
v_add_u32 v118, 4, v117
v_cmp_eq_u32 s[68:69], 0, v57
v_sub_u32 v58, 31, v117
    s_nop 0
v_cndmask_b32 v59, v118, v117, s[68:69]
v_sub_u32 v59, 32, v59
v_cndmask_b32 v117, v117, v58, vcc
v_cndmask_b32 v118, v118, v59, vcc
v_bfe_u32 v56, v117, 1, 1
v_lshrrev_b32 v57, 2, v117
v_xor_b32 v56, v56, v57
v_and_b32 v57, 3, v117
v_lshl_add_u32 v56, v57, 3, v56
v_lshlrev_b32 v56, 4, v56
v_lshl_add_u32 v117, v2, 9, v56
v_bfe_u32 v56, v118, 1, 1
v_lshrrev_b32 v57, 2, v118
v_xor_b32 v56, v56, v57
v_and_b32 v57, 3, v118
v_lshl_add_u32 v56, v57, 3, v56
v_lshlrev_b32 v56, 4, v56
v_lshl_add_u32 v56, v2, 9, v56
v_lshlrev_b32 v57, 4, v2
v_add_u32 v57, 2048, v57
v_cmp_eq_u32 vcc, 32, v118
    s_nop 1
v_cndmask_b32 v118, v56, v57, vcc
s_mul_i32 s48, s40, 8448
v_add_u32 v117, s48, v117
v_add_u32 v118, s48, v118
s_mul_i32 s48, s40, 16896
s_sub_u32 s48, 8448, s48
v_add_u32 v16, s48, v117
v_add_u32 v17, s48, v118
s_mov_b32 s74, 0
L_chk_st:
v_cmp_ne_u32 vcc, s36, v65
v_cmp_ne_u32 s[66:67], s36, v67
s_or_b64 vcc, vcc, s[66:67]
s_cbranch_vccz L_st_ok
s_add_u32 s74, s74, 1
s_cmp_ge_u32 s74, 60000
s_cbranch_scc1 L_st_ok
buffer_load_dwordx4 v[64:67], v113, s[12:15], s83 offen sc1
s_waitcnt vmcnt(0)
s_branch L_chk_st
L_st_ok:
v_cmp_lt_u32 vcc, v20, v112
    s_nop 1
v_cndmask_b32 v4, v64, v66, vcc
v_cndmask_b32 v7, v66, v64, vcc
v_and_b32 v18, s46, v4
v_lshlrev_b32 v70, 16, v4
v_rcp_f32 v18, v18
v_and_b32 v19, s46, v7
v_lshlrev_b32 v71, 16, v7
v_rcp_f32 v19, v19
v_lshlrev_b32 v96, 16, v8
v_and_b32 v97, s46, v8
v_lshlrev_b32 v56, 16, v12
v_and_b32 v57, s46, v12
v_lshlrev_b32 v98, 16, v9
v_and_b32 v99, s46, v9
v_lshlrev_b32 v58, 16, v13
v_and_b32 v59, s46, v13
v_lshlrev_b32 v100, 16, v10
v_and_b32 v101, s46, v10
v_lshlrev_b32 v60, 16, v14
v_and_b32 v61, s46, v14
v_lshlrev_b32 v102, 16, v11
v_and_b32 v103, s46, v11
v_lshlrev_b32 v62, 16, v15
v_and_b32 v63, s46, v15
v_mul_f32 v18, 0.5, v18
v_mul_f32 v19, 0.5, v19
v_mul_f32 v4, -v70, v18
v_mul_f32 v7, -v71, v19
v_add_f32 v18, 0.5, v18
v_add_f32 v19, 0.5, v19
v_add_f32 v70, v4, v7
v_sub_f32 v71, v4, v7
v_fma_f32 v8, v96, v18, v70
v_fma_f32 v96, v96, v18, v71
v_fma_f32 v9, v97, v18, v70
v_fma_f32 v97, v97, v18, v71
v_fma_f32 v10, v98, v18, v70
v_fma_f32 v98, v98, v18, v71
v_fma_f32 v11, v99, v18, v70
v_fma_f32 v99, v99, v18, v71
v_fma_f32 v12, v100, v18, v70
v_fma_f32 v100, v100, v18, v71
v_fma_f32 v13, v101, v18, v70
v_fma_f32 v101, v101, v18, v71
v_fma_f32 v14, v102, v18, v70
v_fma_f32 v102, v102, v18, v71
v_fma_f32 v15, v103, v18, v70
v_fma_f32 v103, v103, v18, v71
s_cmp_eq_u32 s40, 0
s_cbranch_scc1 L_dir1
v_fma_f32 v108, v56, v19, v8
v_fma_f32 v76, -v56, v19, v96
v_fma_f32 v104, v57, v19, v9
v_fma_f32 v72, -v57, v19, v97
v_fma_f32 v105, v58, v19, v10
v_fma_f32 v73, -v58, v19, v98
v_fma_f32 v106, v59, v19, v11
v_fma_f32 v74, -v59, v19, v99
v_fma_f32 v107, v60, v19, v12
v_fma_f32 v75, -v60, v19, v100
v_fma_f32 v109, v61, v19, v13
v_fma_f32 v77, -v61, v19, v101
v_fma_f32 v110, v62, v19, v14
v_fma_f32 v78, -v62, v19, v102
v_fma_f32 v111, v63, v19, v15
v_fma_f32 v79, -v63, v19, v103
s_branch L_dir2
L_dir1:
v_fma_f32 v72, v56, v19, v8
v_fma_f32 v104, -v56, v19, v96
v_fma_f32 v73, v57, v19, v9
v_fma_f32 v105, -v57, v19, v97
v_fma_f32 v74, v58, v19, v10
v_fma_f32 v106, -v58, v19, v98
v_fma_f32 v75, v59, v19, v11
v_fma_f32 v107, -v59, v19, v99
v_fma_f32 v76, v60, v19, v12
v_fma_f32 v108, -v60, v19, v100
v_fma_f32 v77, v61, v19, v13
v_fma_f32 v109, -v61, v19, v101
v_fma_f32 v78, v62, v19, v14
v_fma_f32 v110, -v62, v19, v102
v_fma_f32 v79, v63, v19, v15
v_fma_f32 v111, -v63, v19, v103
L_dir2:
s_waitcnt lgkmcnt(0)
s_barrier
ds_read_b128 v[40:43], v119 offset:47104
ds_read_b128 v[44:47], v119 offset:48128
ds_read_b128 v[48:51], v119 offset:49152
ds_read_b128 v[52:55], v119 offset:50176
s_mov_b32 s74, 0
s_waitcnt vmcnt(0)
L_sweep:
v_xor_b32 v80, v80, v92
v_xor_b32 v81, v81, v93
v_xor_b32 v82, v82, v94
v_xor_b32 v83, v83, v95
v_xor_b32 v84, v84, v92
v_xor_b32 v85, v85, v93
v_xor_b32 v86, v86, v94
v_xor_b32 v87, v87, v95
v_or3_b32 v4, v80, v81, v82
v_xor_b32 v7, s36, v89
v_or3_b32 v4, v4, v83, v84
v_or3_b32 v4, v4, v85, v86
v_or_b32 v4, v4, v87
v_and_or_b32 v4, v4, s47, v7
    s_nop 1
v_or_b32_dpp v4, v4, v4 quad_perm:[1,0,3,2] row_mask:0xf bank_mask:0xf
    s_nop 1
v_or_b32_dpp v4, v4, v4 quad_perm:[2,3,0,1] row_mask:0xf bank_mask:0xf
v_cmp_ne_u32 vcc, 0, v4
s_cbranch_vccz L_sweep_ok
s_add_u32 s74, s74, 1
s_cmp_ge_u32 s74, 60000
s_cbranch_scc1 L_sweep_ok
s_mov_b64 s[64:65], vcc
s_and_b64 exec, vcc, 0xffff
s_cbranch_execz L_noux
buffer_load_dwordx2 v[88:89], v5, s[12:15], s5 offen sc1
L_noux:
s_mov_b64 exec, s[64:65]
buffer_load_dwordx4 v[80:83], v114, s[12:15], s4 offen sc1
buffer_load_dwordx4 v[84:87], v114, s[12:15], s4 offen offset:2048 sc1
s_waitcnt vmcnt(0)
s_branch L_sweep
L_sweep_ok:
s_mov_b64 exec, -1
ds_write2_b32 v115, v80, v84 offset0:0 offset1:1
ds_write2_b32 v115, v81, v85 offset0:32 offset1:33
ds_write2_b32 v116, v82, v86 offset0:64 offset1:65
ds_write2_b32 v116, v83, v87 offset0:96 offset1:97
s_mov_b64 exec, 0xffff
ds_write_b32 v23, v88 offset:2048
s_mov_b64 exec, -1
s_mov_b64 exec, 0xffff
buffer_load_dwordx2 v[68:69], v6, s[12:15], s6 offen sc1
s_mov_b64 exec, -1
v_lshrrev_b32 v22, 3, v1
v_add_u32 v23, -1, v22
s_lshl_b32 s56, s77, 8
s_add_u32 s56, s56, s39
s_lshl_b32 s57, s40, 3
s_lshl_b32 s57, 0xff, s57
s_mov_b32 s60, 0
s_waitcnt lgkmcnt(0)
s_barrier
ds_read_b128 v[80:83], v117 offset:29184
ds_read_b128 v[84:87], v118 offset:29184
ds_read_b128 v[88:91], v117 offset:31296
ds_read_b128 v[92:95], v118 offset:31296
ds_read_b128 v[56:59], v117 offset:33408
ds_read_b128 v[60:63], v118 offset:33408
s_waitcnt lgkmcnt(5)
v_mfma_f32_16x16x32_f16 v[72:75], v[80:83], v[24:27], v[72:75]
ds_read_b128 v[80:83], v117 offset:35520
s_waitcnt lgkmcnt(5)
v_mfma_f32_16x16x32_f16 v[76:79], v[84:87], v[24:27], v[76:79]
ds_read_b128 v[84:87], v118 offset:35520
s_waitcnt lgkmcnt(5)
v_mfma_f32_16x16x32_f16 v[72:75], v[88:91], v[28:31], v[72:75]
ds_read_b128 v[88:91], v16 offset:29184
s_waitcnt lgkmcnt(5)
v_mfma_f32_16x16x32_f16 v[76:79], v[92:95], v[28:31], v[76:79]
ds_read_b128 v[92:95], v17 offset:29184
s_waitcnt lgkmcnt(5)
v_mfma_f32_16x16x32_f16 v[72:75], v[56:59], v[32:35], v[72:75]
ds_read_b128 v[56:59], v16 offset:31296
s_waitcnt lgkmcnt(5)
v_mfma_f32_16x16x32_f16 v[76:79], v[60:63], v[32:35], v[76:79]
ds_read_b128 v[60:63], v17 offset:31296
s_waitcnt lgkmcnt(5)
v_mfma_f32_16x16x32_f16 v[72:75], v[80:83], v[36:39], v[72:75]
ds_read_b128 v[80:83], v16 offset:33408
s_waitcnt lgkmcnt(5)
v_mfma_f32_16x16x32_f16 v[76:79], v[84:87], v[36:39], v[76:79]
ds_read_b128 v[84:87], v17 offset:33408
s_waitcnt lgkmcnt(5)
v_mfma_f32_16x16x32_f16 v[104:107], v[88:91], v[40:43], v[104:107]
ds_read_b128 v[88:91], v16 offset:35520
s_waitcnt lgkmcnt(5)
v_mfma_f32_16x16x32_f16 v[108:111], v[92:95], v[40:43], v[108:111]
ds_read_b128 v[92:95], v17 offset:35520
s_waitcnt lgkmcnt(5)
v_mfma_f32_16x16x32_f16 v[104:107], v[56:59], v[44:47], v[104:107]
s_waitcnt lgkmcnt(4)
v_mfma_f32_16x16x32_f16 v[108:111], v[60:63], v[44:47], v[108:111]
s_waitcnt lgkmcnt(3)
v_mfma_f32_16x16x32_f16 v[104:107], v[80:83], v[48:51], v[104:107]
s_waitcnt lgkmcnt(2)
v_mfma_f32_16x16x32_f16 v[108:111], v[84:87], v[48:51], v[108:111]
s_mov_b64 exec, 0xffff
s_mov_b32 s74, 0
s_waitcnt vmcnt(0)
L_poll_i:
v_cmp_ne_u32 vcc, s36, v69
s_cbranch_vccz L_got_i
s_add_u32 s74, s74, 1
s_cmp_ge_u32 s74, 60000
s_cbranch_scc1 L_got_i
buffer_load_dwordx2 v[68:69], v6, s[12:15], s6 offen sc1
s_waitcnt vmcnt(0)
s_branch L_poll_i
L_got_i:
v_xor_b32 v23, v23, v68
v_add_u32 v22, v22, v23
v_and_b32 v4, 15, v22
v_and_b32 v7, 0x30f, v22
v_cmp_eq_u32 vcc, s39, v4
v_cmp_eq_u32 s[66:67], s56, v7
s_mov_b32 s41, vcc_lo
v_mbcnt_lo_u32_b32 v4, vcc_lo, 0
v_and_b32 v4, 7, v4
s_and_b32 s42, s66, s57
v_cmp_eq_u32 vcc, s3, v4
s_and_b32 s75, vcc_lo, s41
s_mov_b64 exec, -1
v_readlane_b32 s48, v68, 0
s_and_b32 s48, s48, 0x8000
s_or_b32 s48, s48, s74
s_cbranch_scc0 L_g2b
v_lshlrev_b32 v23, 10, v1
s_lshl_b32 s48, s82, 7
s_add_u32 s48, s48, 196608
s_cmp_lt_u32 s82, 4
s_cselect_b64 exec, 0xff, 63
s_mov_b32 s74, 0
L_poll_h:
buffer_load_dword v4, v23, s[12:15], s48 offen sc1
s_add_u32 s74, s74, 1
s_waitcnt vmcnt(0)
v_cmp_ne_u32 vcc, s36, v4
s_cbranch_vccz L_got_h
s_mov_b64 exec, vcc
s_cmp_lt_u32 s74, 60000
s_cbranch_scc1 L_poll_h
L_got_h:
s_mov_b64 exec, -1
L_g2b:
s_cmp_eq_u32 s75, 0
s_cbranch_scc1 L_nofs_3
s_mov_b32 s60, 1
v_lshrrev_b32 v5, 3, v1
v_and_b32 v4, 7, v1
v_lshlrev_b32 v5, 14, v5
v_lshl_add_u32 v5, v4, 4, v5
s_ff1_i32_b32 s49, s75
s_bitset0_b32 s75, s49
s_sub_u32 s54, 15, s76
s_cmp_lt_u32 s49, 8
s_cselect_b32 s54, s76, s54
s_and_b32 s50, s49, 7
s_lshl_b32 s50, s50, 4
s_add_u32 s50, s50, s54
s_lshl_b32 s50, s50, 7
s_add_u32 s50, s50, 4194304
v_readlane_b32 s52, v68, s49
buffer_load_dwordx4 v[8:11], v5, s[12:15], s50 offen sc1
s_add_u32 s51, s50, 131072
buffer_load_dwordx4 v[12:15], v5, s[12:15], s51 offen sc1
s_add_u32 s51, s50, 262144
buffer_load_dwordx4 v[96:99], v5, s[12:15], s51 offen sc1
s_add_u32 s51, s50, 393216
buffer_load_dwordx4 v[100:103], v5, s[12:15], s51 offen sc1
s_add_u32 s51, s50, 524288
buffer_load_dwordx4 v[64:67], v5, s[12:15], s51 offen sc1
s_add_u32 s51, s50, 655360
buffer_load_dwordx4 v[120:123], v5, s[12:15], s51 offen sc1
s_add_u32 s51, s50, 786432
buffer_load_dwordx4 v[124:127], v5, s[12:15], s51 offen sc1
L_nofs_3:
s_waitcnt lgkmcnt(1)
v_mfma_f32_16x16x32_f16 v[104:107], v[88:91], v[52:55], v[104:107]
s_waitcnt lgkmcnt(0)
v_mfma_f32_16x16x32_f16 v[108:111], v[92:95], v[52:55], v[108:111]
s_cmp_eq_u32 s40, 0
s_cbranch_scc1 L_dir3
    s_nop 3
v_add_f32 v25, v104, v72
v_sub_f32 v33, v104, v72
v_add_f32 v26, v105, v73
v_sub_f32 v34, v105, v73
v_add_f32 v27, v106, v74
v_sub_f32 v35, v106, v74
v_add_f32 v28, v107, v75
v_sub_f32 v36, v107, v75
v_add_f32 v24, v108, v76
v_sub_f32 v32, v108, v76
v_add_f32 v29, v109, v77
v_sub_f32 v37, v109, v77
v_add_f32 v30, v110, v78
v_sub_f32 v38, v110, v78
v_add_f32 v31, v111, v79
v_sub_f32 v39, v111, v79
s_branch L_dir4
L_dir3:
s_nop 4
v_pk_add_f32 v[24:25], v[72:73], v[104:105]
v_pk_add_f32 v[32:33], v[72:73], v[104:105] neg_lo:[0,1] neg_hi:[0,1]
v_pk_add_f32 v[26:27], v[74:75], v[106:107]
v_pk_add_f32 v[34:35], v[74:75], v[106:107] neg_lo:[0,1] neg_hi:[0,1]
v_pk_add_f32 v[28:29], v[76:77], v[108:109]
v_pk_add_f32 v[36:37], v[76:77], v[108:109] neg_lo:[0,1] neg_hi:[0,1]
v_pk_add_f32 v[30:31], v[78:79], v[110:111]
v_pk_add_f32 v[38:39], v[78:79], v[110:111] neg_lo:[0,1] neg_hi:[0,1]
L_dir4:
s_cmp_lg_u32 s41, 0
s_cbranch_scc1 L_fix
v_cvt_pk_bf16_f32 v80, v24, v25
v_cvt_pk_bf16_f32 v81, v26, v27
v_cvt_pk_bf16_f32 v82, v28, v29
v_cvt_pk_bf16_f32 v83, v30, v31
buffer_store_dwordx4 v[80:83], v112, s[16:19], s7 offen sc1
v_cvt_pk_bf16_f32 v84, v32, v33
v_cvt_pk_bf16_f32 v85, v34, v35
v_cvt_pk_bf16_f32 v86, v36, v37
v_cvt_pk_bf16_f32 v87, v38, v39
buffer_store_dwordx4 v[84:87], v20, s[16:19], s7 offen sc1
L_fin:
L_end:
s_endpgm
L_cgen:
v_mul_f32 v94, 0x3d800000, v80
v_mul_f32 v95, 0x40800000, v81
v_mul_f32 v95, v94, v95
v_mov_b32 v82, v95
v_fmamk_f32 v83, v94, 0x3f800000, v95
v_fmamk_f32 v84, v94, 0x40000000, v95
v_fmamk_f32 v85, v94, 0x40400000, v95
v_cos_f32 v86, v82
v_sin_f32 v90, v82
v_cos_f32 v87, v83
v_sin_f32 v91, v83
v_cos_f32 v88, v84
v_sin_f32 v92, v84
v_cos_f32 v89, v85
v_sin_f32 v93, v85
v_mul_f32 v86, 0x3f910236, v86
v_mul_f32 v90, 0x3f910236, v90
v_mul_f32 v87, 0x3f910236, v87
v_mul_f32 v91, 0x3f910236, v91
v_mul_f32 v88, 0x3f910236, v88
v_mul_f32 v92, 0x3f910236, v92
v_mul_f32 v89, 0x3f910236, v89
v_mul_f32 v93, 0x3f910236, v93
v_cvt_pk_bf16_f32 v96, v86, v90
v_cvt_pk_bf16_f32 v100, -v90, v86
v_cvt_pk_bf16_f32 v97, v87, v91
v_cvt_pk_bf16_f32 v101, -v91, v87
v_cvt_pk_bf16_f32 v98, v88, v92
v_cvt_pk_bf16_f32 v102, -v92, v88
v_cvt_pk_bf16_f32 v99, v89, v93
v_cvt_pk_bf16_f32 v103, -v93, v89
s_branch L_cgw
L_cg1:
v_mul_f32 v94, 0x3b000000, v80
v_mul_f32 v95, 0x41000000, v81
v_mul_f32 v95, v94, v95
v_mov_b32 v82, v95
v_fmamk_f32 v83, v94, 0x40000000, v95
v_fmamk_f32 v84, v94, 0x40800000, v95
v_fmamk_f32 v85, v94, 0x40c00000, v95
v_cos_f32 v96, v82
v_sin_f32 v100, v82
v_cos_f32 v97, v83
v_sin_f32 v101, v83
v_cos_f32 v98, v84
v_sin_f32 v102, v84
v_cos_f32 v99, v85
v_sin_f32 v103, v85
s_branch L_cgw
L_cg2:
v_mul_f32 v94, 0x3b000000, v80
v_mul_f32 v95, 0x41000000, v81
v_mul_f32 v95, v94, v95
v_fmamk_f32 v82, v94, 0x3f800000, v95
v_fmamk_f32 v83, v94, 0x40400000, v95
v_fmamk_f32 v84, v94, 0x40a00000, v95
v_fmamk_f32 v85, v94, 0x40e00000, v95
v_cos_f32 v96, v82
v_sin_f32 v100, v82
v_cos_f32 v97, v83
v_sin_f32 v101, v83
v_cos_f32 v98, v84
v_sin_f32 v102, v84
v_cos_f32 v99, v85
v_sin_f32 v103, v85
s_branch L_cgw
L_cg3:
v_mul_f32 v94, 0x3d000000, v80
v_mul_f32 v95, 0x41000000, v81
v_mul_f32 v95, v94, v95
v_mov_b32 v82, v95
v_fmamk_f32 v83, v94, 0x40000000, v95
v_fmamk_f32 v84, v94, 0x40800000, v95
v_fmamk_f32 v85, v94, 0x40c00000, v95
v_cos_f32 v86, v82
v_sin_f32 v90, v82
v_cos_f32 v87, v83
v_sin_f32 v91, v83
v_cos_f32 v88, v84
v_sin_f32 v92, v84
v_cos_f32 v89, v85
v_sin_f32 v93, v85
v_cvt_pk_f16_f32 v96, v86, v90
v_cvt_pk_f16_f32 v100, -v90, v86
v_cvt_pk_f16_f32 v97, v87, v91
v_cvt_pk_f16_f32 v101, -v91, v87
v_cvt_pk_f16_f32 v98, v88, v92
v_cvt_pk_f16_f32 v102, -v92, v88
v_cvt_pk_f16_f32 v99, v89, v93
v_cvt_pk_f16_f32 v103, -v93, v89
s_branch L_cgw
L_cg4:
v_mul_f32 v94, 0x3d000000, v80
v_mul_f32 v95, 0x41000000, v81
v_mul_f32 v95, v94, v95
v_fmamk_f32 v82, v94, 0x3f800000, v95
v_fmamk_f32 v83, v94, 0x40400000, v95
v_fmamk_f32 v84, v94, 0x40a00000, v95
v_fmamk_f32 v85, v94, 0x40e00000, v95
v_cos_f32 v86, v82
v_sin_f32 v90, v82
v_cos_f32 v87, v83
v_sin_f32 v91, v83
v_cos_f32 v88, v84
v_sin_f32 v92, v84
v_cos_f32 v89, v85
v_sin_f32 v93, v85
v_cvt_pk_f16_f32 v96, v86, v90
v_cvt_pk_f16_f32 v100, -v90, v86
v_cvt_pk_f16_f32 v97, v87, v91
v_cvt_pk_f16_f32 v101, -v91, v87
v_cvt_pk_f16_f32 v98, v88, v92
v_cvt_pk_f16_f32 v102, -v92, v88
v_cvt_pk_f16_f32 v99, v89, v93
v_cvt_pk_f16_f32 v103, -v93, v89
s_branch L_cgw
L_cg5:
v_mul_f32 v94, 0x3d000000, v80
v_mul_f32 v95, 0x41000000, v81
v_mul_f32 v95, v94, v95
v_add_f32 v95, 0x3f000000, v95
v_fmamk_f32 v82, v94, 0x3f800000, v95
v_fmamk_f32 v83, v94, 0x40400000, v95
v_fmamk_f32 v84, v94, 0x40a00000, v95
v_fmamk_f32 v85, v94, 0x40e00000, v95
v_cos_f32 v86, v82
v_sin_f32 v90, v82
v_cos_f32 v87, v83
v_sin_f32 v91, v83
v_cos_f32 v88, v84
v_sin_f32 v92, v84
v_cos_f32 v89, v85
v_sin_f32 v93, v85
v_cvt_pk_f16_f32 v96, v86, v90
v_cvt_pk_f16_f32 v100, -v90, v86
v_cvt_pk_f16_f32 v97, v87, v91
v_cvt_pk_f16_f32 v101, -v91, v87
v_cvt_pk_f16_f32 v98, v88, v92
v_cvt_pk_f16_f32 v102, -v92, v88
v_cvt_pk_f16_f32 v99, v89, v93
v_cvt_pk_f16_f32 v103, -v93, v89
s_branch L_cgw
L_cg6:
v_mul_f32 v94, 0x3d800000, v80
v_mul_f32 v95, 0x40000000, v81
v_mul_f32 v95, v94, v95
v_mov_b32 v82, v95
v_fmamk_f32 v83, v94, 0x3f800000, v95
v_mov_b32 v84, v95
v_fmamk_f32 v85, v94, 0x3f800000, v95
v_and_b32 v94, 1, v3
v_lshlrev_b32 v94, 31, v94
v_or_b32 v94, 0x3e000000, v94
v_add_f32 v82, v82, v94
v_add_f32 v83, v83, v94
v_sub_f32 v84, v84, v94
v_sub_f32 v85, v85, v94
v_cos_f32 v86, v82
v_sin_f32 v90, v82
v_cos_f32 v87, v83
v_sin_f32 v91, v83
v_cos_f32 v88, v84
v_sin_f32 v92, v84
v_cos_f32 v89, v85
v_sin_f32 v93, v85
v_mul_f32 v86, 0x3f1fc970, v86
v_mul_f32 v90, 0x3f1fc970, v90
v_mul_f32 v87, 0x3f1fc970, v87
v_mul_f32 v91, 0x3f1fc970, v91
v_mul_f32 v88, 0x3f1fc970, v88
v_mul_f32 v92, 0x3f1fc970, v92
v_mul_f32 v89, 0x3f1fc970, v89
v_mul_f32 v93, 0x3f1fc970, v93
v_cvt_pk_f16_f32 v96, v86, v90
v_cvt_pk_f16_f32 v100, -v90, v86
v_cvt_pk_f16_f32 v98, v88, -v92
v_cvt_pk_f16_f32 v102, -v92, -v88
v_cvt_pk_f16_f32 v97, v87, v91
v_cvt_pk_f16_f32 v101, -v91, v87
v_cvt_pk_f16_f32 v99, v89, -v93
v_cvt_pk_f16_f32 v103, -v93, -v89
s_branch L_cgw
L_fix:
v_lshlrev_b32 v7, 5, v2
s_mov_b64 s[68:69], 0
s_mov_b64 s[70:71], 0
s_mov_b32 s56, s42
s_cmp_eq_u32 s42, 0
s_cbranch_scc1 L_parked
L_park:
s_ff1_i32_b32 s57, s56
s_bitset0_b32 s56, s57
v_readlane_b32 s58, v22, s57
s_lshl_b32 s57, s57, 7
s_bfe_u32 s59, s58, 0x40004
v_add_u32 v6, s57, v7
v_cmp_eq_u32 vcc, s59, v3
s_bitcmp1_b32 s58, 10
s_mov_b64 exec, vcc
s_cbranch_scc1 L_phi
s_or_b64 s[68:69], s[68:69], vcc
ds_write_b128 v6, v[24:27] offset:2560
ds_write_b128 v6, v[28:31] offset:2576
s_branch L_pnext
L_phi:
s_or_b64 s[70:71], s[70:71], vcc
ds_write_b128 v6, v[32:35] offset:2560
ds_write_b128 v6, v[36:39] offset:2576
L_pnext:
s_mov_b64 exec, -1
s_cmp_lg_u32 s56, 0
s_cbranch_scc1 L_park
L_parked:
v_cvt_pk_bf16_f32 v80, v24, v25
v_cvt_pk_bf16_f32 v81, v26, v27
v_cvt_pk_bf16_f32 v82, v28, v29
v_cvt_pk_bf16_f32 v83, v30, v31
s_not_b64 exec, s[68:69]
buffer_store_dwordx4 v[80:83], v112, s[16:19], s7 offen sc1
s_mov_b64 exec, -1
v_cvt_pk_bf16_f32 v84, v32, v33
v_cvt_pk_bf16_f32 v85, v34, v35
v_cvt_pk_bf16_f32 v86, v36, v37
v_cvt_pk_bf16_f32 v87, v38, v39
s_not_b64 exec, s[70:71]
buffer_store_dwordx4 v[84:87], v20, s[16:19], s7 offen sc1
s_mov_b64 exec, -1
s_cmp_eq_u32 s60, 0
s_waitcnt lgkmcnt(0)
s_barrier
s_cbranch_scc1 L_fin
v_mov_b32 v71, s36
v_and_b32 v18, 0xff, v71
v_bfe_u32 v19, v71, 8, 8
v_bfe_u32 v70, v71, 16, 8
v_lshrrev_b32 v71, 24, v71
v_and_b32 v6, 7, v1
v_lshl_add_u32 v6, v6, 2, v2
v_lshlrev_b32 v7, 2, v6
v_lshlrev_b32 v6, 1, v6
s_lshl_b32 s49, s49, 7
v_add_u32 v23, s49, v7
ds_read_b32 v23, v23 offset:2560
s_ashr_i32 s55, s52, 31
s_not_b32 s55, s55
s_or_b32 s55, s55, 0x80000000
s_xor_b32 s55, s55, s52
s_and_b32 s55, s55, 0xffff0000
v_mov_b32 v21, s55
v_mul_f32 v21, 0xbfb8aa3b, v21
v_exp_f32 v21, v21
    s_nop 0
v_add_f32 v21, 1.0, v21
v_rcp_f32 v21, v21
s_andn2_b32 s53, 2047, s52
s_lshl_b32 s53, s53, 10
s_lshl_b32 s54, s54, 6
s_add_u32 s53, s53, s54
s_mov_b32 s74, 0
s_waitcnt vmcnt(8)
v_xor_b32 v8, v8, v18
v_xor_b32 v9, v9, v19
v_xor_b32 v10, v10, v70
v_xor_b32 v11, v11, v71
v_or3_b32 v4, v8, v9, v10
v_or_b32 v4, v4, v11
s_waitcnt vmcnt(7)
v_xor_b32 v12, v12, v18
v_xor_b32 v13, v13, v19
v_xor_b32 v14, v14, v70
v_xor_b32 v15, v15, v71
v_or3_b32 v4, v4, v12, v13
v_or3_b32 v4, v4, v14, v15
v_pk_add_f32 v[8:9], v[8:9], v[12:13]
v_pk_add_f32 v[10:11], v[10:11], v[14:15]
s_waitcnt vmcnt(6)
v_xor_b32 v96, v96, v18
v_xor_b32 v97, v97, v19
v_xor_b32 v98, v98, v70
v_xor_b32 v99, v99, v71
v_or3_b32 v4, v4, v96, v97
v_or3_b32 v4, v4, v98, v99
v_pk_add_f32 v[8:9], v[8:9], v[96:97]
v_pk_add_f32 v[10:11], v[10:11], v[98:99]
s_waitcnt vmcnt(5)
v_xor_b32 v100, v100, v18
v_xor_b32 v101, v101, v19
v_xor_b32 v102, v102, v70
v_xor_b32 v103, v103, v71
v_or3_b32 v4, v4, v100, v101
v_or3_b32 v4, v4, v102, v103
v_pk_add_f32 v[8:9], v[8:9], v[100:101]
v_pk_add_f32 v[10:11], v[10:11], v[102:103]
s_waitcnt vmcnt(4)
v_xor_b32 v64, v64, v18
v_xor_b32 v65, v65, v19
v_xor_b32 v66, v66, v70
v_xor_b32 v67, v67, v71
v_or3_b32 v4, v4, v64, v65
v_or3_b32 v4, v4, v66, v67
v_pk_add_f32 v[8:9], v[8:9], v[64:65]
v_pk_add_f32 v[10:11], v[10:11], v[66:67]
s_waitcnt vmcnt(3)
v_xor_b32 v120, v120, v18
v_xor_b32 v121, v121, v19
v_xor_b32 v122, v122, v70
v_xor_b32 v123, v123, v71
v_or3_b32 v4, v4, v120, v121
v_or3_b32 v4, v4, v122, v123
v_pk_add_f32 v[8:9], v[8:9], v[120:121]
v_pk_add_f32 v[10:11], v[10:11], v[122:123]
s_waitcnt vmcnt(2)
v_xor_b32 v124, v124, v18
v_xor_b32 v125, v125, v19
v_xor_b32 v126, v126, v70
v_xor_b32 v127, v127, v71
v_or3_b32 v4, v4, v124, v125
v_or3_b32 v4, v4, v126, v127
v_pk_add_f32 v[8:9], v[8:9], v[124:125]
v_pk_add_f32 v[10:11], v[10:11], v[126:127]
v_and_b32 v4, 0xff, v4
v_cmp_ne_u32 vcc, 0, v4
s_cbranch_vccz L_got_p
L_retry_p:
s_add_u32 s74, s74, 1
s_cmp_ge_u32 s74, 60000
s_cbranch_scc1 L_got_p
s_mov_b64 exec, vcc
buffer_load_dwordx4 v[8:11], v5, s[12:15], s50 offen sc1
s_add_u32 s51, s50, 131072
buffer_load_dwordx4 v[12:15], v5, s[12:15], s51 offen sc1
s_add_u32 s51, s50, 262144
buffer_load_dwordx4 v[96:99], v5, s[12:15], s51 offen sc1
s_add_u32 s51, s50, 393216
buffer_load_dwordx4 v[100:103], v5, s[12:15], s51 offen sc1
s_add_u32 s51, s50, 524288
buffer_load_dwordx4 v[64:67], v5, s[12:15], s51 offen sc1
s_add_u32 s51, s50, 655360
buffer_load_dwordx4 v[120:123], v5, s[12:15], s51 offen sc1
s_add_u32 s51, s50, 786432
buffer_load_dwordx4 v[124:127], v5, s[12:15], s51 offen sc1
L_poll_p:
s_waitcnt vmcnt(6)
v_xor_b32 v8, v8, v18
v_xor_b32 v9, v9, v19
v_xor_b32 v10, v10, v70
v_xor_b32 v11, v11, v71
v_or3_b32 v4, v8, v9, v10
v_or_b32 v4, v4, v11
s_waitcnt vmcnt(5)
v_xor_b32 v12, v12, v18
v_xor_b32 v13, v13, v19
v_xor_b32 v14, v14, v70
v_xor_b32 v15, v15, v71
v_or3_b32 v4, v4, v12, v13
v_or3_b32 v4, v4, v14, v15
v_pk_add_f32 v[8:9], v[8:9], v[12:13]
v_pk_add_f32 v[10:11], v[10:11], v[14:15]
s_waitcnt vmcnt(4)
v_xor_b32 v96, v96, v18
v_xor_b32 v97, v97, v19
v_xor_b32 v98, v98, v70
v_xor_b32 v99, v99, v71
v_or3_b32 v4, v4, v96, v97
v_or3_b32 v4, v4, v98, v99
v_pk_add_f32 v[8:9], v[8:9], v[96:97]
v_pk_add_f32 v[10:11], v[10:11], v[98:99]
s_waitcnt vmcnt(3)
v_xor_b32 v100, v100, v18
v_xor_b32 v101, v101, v19
v_xor_b32 v102, v102, v70
v_xor_b32 v103, v103, v71
v_or3_b32 v4, v4, v100, v101
v_or3_b32 v4, v4, v102, v103
v_pk_add_f32 v[8:9], v[8:9], v[100:101]
v_pk_add_f32 v[10:11], v[10:11], v[102:103]
s_waitcnt vmcnt(2)
v_xor_b32 v64, v64, v18
v_xor_b32 v65, v65, v19
v_xor_b32 v66, v66, v70
v_xor_b32 v67, v67, v71
v_or3_b32 v4, v4, v64, v65
v_or3_b32 v4, v4, v66, v67
v_pk_add_f32 v[8:9], v[8:9], v[64:65]
v_pk_add_f32 v[10:11], v[10:11], v[66:67]
s_waitcnt vmcnt(1)
v_xor_b32 v120, v120, v18
v_xor_b32 v121, v121, v19
v_xor_b32 v122, v122, v70
v_xor_b32 v123, v123, v71
v_or3_b32 v4, v4, v120, v121
v_or3_b32 v4, v4, v122, v123
v_pk_add_f32 v[8:9], v[8:9], v[120:121]
v_pk_add_f32 v[10:11], v[10:11], v[122:123]
s_waitcnt vmcnt(0)
v_xor_b32 v124, v124, v18
v_xor_b32 v125, v125, v19
v_xor_b32 v126, v126, v70
v_xor_b32 v127, v127, v71
v_or3_b32 v4, v4, v124, v125
v_or3_b32 v4, v4, v126, v127
v_pk_add_f32 v[8:9], v[8:9], v[124:125]
v_pk_add_f32 v[10:11], v[10:11], v[126:127]
v_and_b32 v4, 0xff, v4
v_cmp_ne_u32 vcc, 0, v4
s_cbranch_vccnz L_retry_p
L_got_p:
s_mov_b64 exec, -1
s_nop 1
v_permlane32_swap_b32 v8, v10
v_permlane32_swap_b32 v9, v11
v_add_f32 v8, v8, v10
v_add_f32 v9, v9, v11
    s_nop 1
v_permlane16_swap_b32 v8, v9
v_add_f32 v8, v8, v9
s_waitcnt lgkmcnt(0)
    s_nop 0
v_add_f32_dpp v8, v8, v8 row_ror:8 row_mask:0xf bank_mask:0xf
s_mov_b32 exec_lo, 0x00ff00ff
v_fma_f32 v23, v8, v21, v23
s_mov_b32 exec_hi, 0x00ff00ff
v_cvt_pk_bf16_f32 v23, v23, v23
buffer_store_short v23, v6, s[16:19], s53 offen sc1
s_mov_b64 exec, -1
s_cmp_eq_u32 s75, 0
s_cbranch_scc1 L_fin
s_ff1_i32_b32 s49, s75
s_bitset0_b32 s75, s49
s_sub_u32 s54, 15, s76
s_cmp_lt_u32 s49, 8
s_cselect_b32 s54, s76, s54
s_and_b32 s50, s49, 7
s_lshl_b32 s50, s50, 4
s_add_u32 s50, s50, s54
s_lshl_b32 s50, s50, 7
s_add_u32 s50, s50, 4194304
v_readlane_b32 s52, v68, s49
buffer_load_dwordx4 v[8:11], v5, s[12:15], s50 offen sc1
s_add_u32 s51, s50, 131072
buffer_load_dwordx4 v[12:15], v5, s[12:15], s51 offen sc1
s_add_u32 s51, s50, 262144
buffer_load_dwordx4 v[96:99], v5, s[12:15], s51 offen sc1
s_add_u32 s51, s50, 393216
buffer_load_dwordx4 v[100:103], v5, s[12:15], s51 offen sc1
s_add_u32 s51, s50, 524288
buffer_load_dwordx4 v[64:67], v5, s[12:15], s51 offen sc1
s_add_u32 s51, s50, 655360
buffer_load_dwordx4 v[120:123], v5, s[12:15], s51 offen sc1
s_add_u32 s51, s50, 786432
buffer_load_dwordx4 v[124:127], v5, s[12:15], s51 offen sc1
s_lshl_b32 s49, s49, 7
v_add_u32 v23, s49, v7
ds_read_b32 v23, v23 offset:2560
s_ashr_i32 s55, s52, 31
s_not_b32 s55, s55
s_or_b32 s55, s55, 0x80000000
s_xor_b32 s55, s55, s52
s_and_b32 s55, s55, 0xffff0000
v_mov_b32 v21, s55
v_mul_f32 v21, 0xbfb8aa3b, v21
v_exp_f32 v21, v21
    s_nop 0
v_add_f32 v21, 1.0, v21
v_rcp_f32 v21, v21
s_andn2_b32 s53, 2047, s52
s_lshl_b32 s53, s53, 10
s_lshl_b32 s54, s54, 6
s_add_u32 s53, s53, s54
s_mov_b32 s74, 0
s_branch L_poll_p
L_notp1:
v_mov_b32 v99, 0
v_mov_b32 v100, 1
v_and_b32 v5, 7, v1
v_lshlrev_b32 v5, 2, v5
ds_write_b32 v5, v99 offset:544
s_bfe_u32 s49, s2, 0x20004
s_lshl_b32 s49, s49, 3
s_add_u32 s49, s49, s82
s_lshl_b32 s42, s49, 1
s_bfe_u32 s50, s2, 0x10003
s_add_u32 s42, s42, s50
s_cmp_lt_u32 s49, 28
s_cselect_b32 s41, 1, 3
s_cmp_ge_u32 s2, 192
s_cselect_b32 s41, 2, s41
s_waitcnt lgkmcnt(0)
s_barrier
v_mov_b32 v20, 0
s_cmp_eq_u32 s41, 1
s_cbranch_scc1 L_ldn
s_cmp_lg_u32 s2, 255
s_cbranch_scc1 L_ldn2
L_ldn:
buffer_load_dword v20, off, s[12:15], 0 offset:0 sc1
L_ldn2:
s_cmp_ge_u32 s3, 4
s_cbranch_scc1 L_loaders
s_waitcnt vmcnt(0)
v_readfirstlane_b32 s36, v20
s_mul_i32 s36, s36, 0x9E3779B1
s_add_u32 s36, s36, 0x7F4A7C15
s_cmp_eq_u32 s41, 1
s_cbranch_scc1 L_top8
s_cmp_lg_u32 s2, 255
s_cbranch_scc1 L_fin
s_cmp_lg_u32 s3, 1
s_cbranch_scc1 L_fin
v_lshlrev_b32 v5, 7, v1
s_mov_b32 s48, 131072
s_mov_b32 s74, 0
s_mov_b32 exec_hi, 0x00ffffff
L_pst:
s_sleep 16
buffer_load_dword v8, v5, s[12:15], s48 offen sc1
s_add_u32 s74, s74, 1
s_waitcnt vmcnt(0)
v_cmp_ne_u32 vcc, s36, v8
s_cbranch_vccz L_pst_ok
s_cmp_lt_u32 s74, 60000
s_cbranch_scc1 L_pst
L_pst_ok:
v_mov_b32 v8, s36
s_mov_b64 exec, 1
buffer_store_dword v8, off, s[12:15], 0 offset:0 sc1
s_mov_b64 exec, -1
s_branch L_fin
L_loaders:
s_cmp_eq_u32 s41, 1
s_cbranch_scc1 L_moe_ld
s_cmp_eq_u32 s41, 3
s_cbranch_scc1 L_fin
s_waitcnt vmcnt(0)
s_bfe_u32 s56, s2, 0x30003
s_lshl_b32 s56, s56, 2
s_add_u32 s56, s56, s3
s_sub_u32 s56, s56, 4
v_lshrrev_b32 v4, 3, v1
v_mul_u32_u24 v4, 3584, v4
v_and_b32 v5, 7, v1
v_lshl_add_u32 v4, v5, 4, v4
v_lshlrev_b32 v5, 4, v1
s_and_b32 s57, s56, 3
s_lshl_b32 s57, s57, 3
s_add_u32 s57, s57, s82
s_lshr_b32 s56, s56, 2
s_cmp_ge_u32 s57, 28
s_cbranch_scc1 L_nopf_4
s_mov_b32 m0, 11264
s_mul_i32 s58, s56, 28672
s_lshl_b32 s59, s57, 7
s_add_u32 s58, s58, s59
s_lshl_b32 s59, s57, 6
s_add_u32 s59, s59, s56
s_lshl_b32 s59, s59, 10
s_sub_u32 s59, s59, 0
s_mov_b32 s60, 0
L_pfd_5:
buffer_load_dwordx4 v5, s[32:35], s59 offen lds
s_add_u32 s59, s59, 8192
s_add_u32 s60, s60, 1
s_cmp_lt_u32 s60, 8
s_cbranch_scc1 L_pfd_5
L_nopf_4:
s_branch L_fin
L_moe_ld:
s_waitcnt vmcnt(0)
v_lshrrev_b32 v4, 2, v1
v_mul_u32_u24 v4, 3584, v4
v_and_b32 v5, 3, v1
v_lshl_add_u32 v4, v5, 4, v4
v_lshlrev_b32 v22, 13, v2
v_lshl_add_u32 v22, v3, 3, v22
v_add_u32 v23, 4096, v22
s_lshl_b32 s54, s42, 15
s_lshl_b32 s55, s3, 7
s_add_u32 s54, s54, s55
buffer_load_dwordx2 v[108:109], v22, s[32:35], s54 offen offset:0
buffer_load_dwordx2 v[110:111], v22, s[32:35], s54 offen offset:1024
buffer_load_dwordx2 v[112:113], v22, s[32:35], s54 offen offset:2048
buffer_load_dwordx2 v[114:115], v22, s[32:35], s54 offen offset:3072
buffer_load_dwordx2 v[116:117], v23, s[32:35], s54 offen offset:0
buffer_load_dwordx2 v[118:119], v23, s[32:35], s54 offen offset:1024
buffer_load_dwordx2 v[120:121], v23, s[32:35], s54 offen offset:2048
buffer_load_dwordx2 v[122:123], v23, s[32:35], s54 offen offset:3072
s_sub_u32 s50, s3, 4
s_mul_i32 s48, s50, 229376
s_lshl_b32 s49, s42, 6
s_add_u32 s48, s48, s49
s_lshl_b32 s50, s50, 12
s_add_u32 m0, s50, 12288
    s_nop 0
buffer_load_dwordx4 v4, s[24:27], s48 offen lds
s_add_u32 m0, s50, 45088
    s_nop 0
buffer_load_dwordx4 v4, s[28:31], s48 offen lds
s_add_u32 s48, s48, 57344
s_add_u32 m0, s50, 13312
    s_nop 0
buffer_load_dwordx4 v4, s[24:27], s48 offen lds
s_add_u32 m0, s50, 46112
    s_nop 0
buffer_load_dwordx4 v4, s[28:31], s48 offen lds
s_add_u32 s48, s48, 57344
s_add_u32 m0, s50, 14336
    s_nop 0
buffer_load_dwordx4 v4, s[24:27], s48 offen lds
s_add_u32 m0, s50, 47136
    s_nop 0
buffer_load_dwordx4 v4, s[28:31], s48 offen lds
s_add_u32 s48, s48, 57344
s_add_u32 m0, s50, 15360
    s_nop 0
buffer_load_dwordx4 v4, s[24:27], s48 offen lds
s_add_u32 m0, s50, 48160
    s_nop 0
buffer_load_dwordx4 v4, s[28:31], s48 offen lds
s_add_u32 s48, s48, 745472
s_add_u32 m0, s50, 28672
    s_nop 0
buffer_load_dwordx4 v4, s[24:27], s48 offen lds
s_add_u32 m0, s50, 61472
    s_nop 0
buffer_load_dwordx4 v4, s[28:31], s48 offen lds
s_add_u32 s48, s48, 57344
s_add_u32 m0, s50, 29696
    s_nop 0
buffer_load_dwordx4 v4, s[24:27], s48 offen lds
s_add_u32 m0, s50, 62496
    s_nop 0
buffer_load_dwordx4 v4, s[28:31], s48 offen lds
s_add_u32 s48, s48, 57344
v_mov_b32 v11, v4
v_and_b32 v4, 7, v1
v_lshlrev_b32 v5, 2, v4
v_mov_b32 v7, 0
v_mul_u32_u24 v6, 1056, v4
v_lshl_add_u32 v6, v2, 4, v6
s_lshl_b32 s56, s3, 8
s_lshl_b32 s57, s42, 14
s_add_u32 s56, s56, s57
s_add_u32 s56, s56, 4194304
s_add_u32 s57, s56, 128
s_mov_b32 s58, 0x07060500
s_mov_b32 s59, 0x07060501
s_mov_b32 s60, 0x07060502
s_mov_b32 s61, 0x07060503
v_lshrrev_b32 v8, 2, v3
v_lshl_add_u32 v8, v2, 3, v8
v_lshlrev_b32 v8, 6, v8
v_and_b32 v9, 1, v3
v_lshl_add_u32 v8, v9, 3, v8
v_bfe_u32 v9, v3, 1, 1
v_mul_u32_u24 v9, 32800, v9
s_lshl_b32 s51, s3, 4
s_add_u32 s51, s51, 12224
v_add3_u32 v8, v8, v9, s51
v_mov_b32 v12, s45
v_mov_b32 v13, s45
v_mov_b32 v14, s45
v_mov_b32 v15, s45
s_mov_b32 s74, 0
L_wseen:
ds_read_b32 v98, v99 offset:556
s_add_u32 s74, s74, 1
s_waitcnt lgkmcnt(0)
v_readfirstlane_b32 s51, v98
s_cmp_ge_u32 s51, 4
s_cbranch_scc1 L_wseen_ok
s_cmp_lt_u32 s74, 480000
s_cbranch_scc1 L_wseen
L_wseen_ok:
s_add_u32 m0, s50, 30720
    s_nop 0
buffer_load_dwordx4 v11, s[24:27], s48 offen lds
s_add_u32 m0, s50, 63520
    s_nop 0
buffer_load_dwordx4 v11, s[28:31], s48 offen lds
s_add_u32 s48, s48, 57344
s_add_u32 m0, s50, 31744
    s_nop 0
buffer_load_dwordx4 v11, s[24:27], s48 offen lds
s_add_u32 m0, s50, 64544
    s_nop 0
buffer_load_dwordx4 v11, s[28:31], s48 offen lds
v_readfirstlane_b32 s36, v20
s_mul_i32 s36, s36, 0x9E3779B1
s_add_u32 s36, s36, 0x7F4A7C15
s_branch L_wteam
L_top8:
v_lshrrev_b32 v16, 2, v0
v_and_b32 v17, 3, v0
v_lshlrev_b32 v4, 7, v16
v_lshl_add_u32 v4, v17, 4, v4
v_lshl_add_u32 v16, v17, 8, v16
v_sub_u32 v16, 2047, v16
v_subrev_u32 v17, 1024, v16
v_subrev_u32 v18, 128, v16
v_subrev_u32 v19, 1152, v16
v_subrev_u32 v20, 64, v16
v_subrev_u32 v21, 64, v17
v_subrev_u32 v22, 64, v18
v_subrev_u32 v23, 64, v19
s_lshl_b32 s49, s3, 6
v_and_b32 v6, 60, v1
v_add_u32 v6, s49, v6
v_and_b32 v7, 3, v1
v_lshlrev_b32 v7, 6, v7
s_lshl_b32 s49, s3, 5
v_lshl_add_u32 v5, v2, 3, s49
s_mov_b32 s74, 0
s_lshl_b32 s48, s82, 14
s_add_u32 s48, s48, 524288
s_add_u32 s49, s48, 8192
L_poll_r:
buffer_load_dwordx4 v[8:11], v4, s[12:15], s48 offen sc1
buffer_load_dwordx4 v[12:15], v4, s[12:15], s49 offen sc1
s_add_u32 s74, s74, 1
s_waitcnt vmcnt(1)
v_cmp_ne_u32 vcc, s36, v9
v_cmp_ne_u32 s[66:67], s36, v11
s_waitcnt vmcnt(0)
v_cmp_ne_u32 s[68:69], s36, v13
v_cmp_ne_u32 s[70:71], s36, v15
s_or_b64 vcc, vcc, s[66:67]
s_or_b64 s[68:69], s[68:69], s[70:71]
s_or_b64 vcc, vcc, s[68:69]
s_cbranch_vccz L_got_r
s_mov_b64 exec, vcc
s_cmp_lt_u32 s74, 60000
s_cbranch_scc1 L_poll_r
L_got_r:
s_mov_b64 exec, -1
s_mov_b64 exec, 1
ds_add_u32 v99, v100 offset:556
s_mov_b64 exec, -1
v_lshl_or_b32 v104, v8, 16, v16
v_and_or_b32 v105, v8, s46, v17
v_lshl_or_b32 v106, v10, 16, v18
v_and_or_b32 v107, v10, s46, v19
v_lshl_or_b32 v108, v12, 16, v20
v_and_or_b32 v109, v12, s46, v21
v_lshl_or_b32 v110, v14, 16, v22
v_and_or_b32 v111, v14, s46, v23
v_max3_u32 v8, v104, v105, v106
v_max3_u32 v12, v108, v109, v110
v_max_u32 v40, v8, v107
v_max_u32 v44, v12, v111
v_med3_u32 v9, v104, v105, v106
v_med3_u32 v13, v108, v109, v110
v_max_u32_dpp v112, v40, v40 row_ror:8 row_mask:0xf bank_mask:0xf
v_max_u32_dpp v114, v44, v44 row_ror:8 row_mask:0xf bank_mask:0xf
v_min3_u32 v10, v104, v105, v106
v_min3_u32 v14, v108, v109, v110
v_max_u32_dpp v112, v112, v112 row_ror:4 row_mask:0xf bank_mask:0xf
v_max_u32_dpp v114, v114, v114 row_ror:4 row_mask:0xf bank_mask:0xf
v_med3_u32 v41, v8, v9, v107
v_med3_u32 v45, v12, v13, v111
v_max_u32_dpp v112, v112, v112 row_ror:2 row_mask:0xf bank_mask:0xf
v_max_u32_dpp v114, v114, v114 row_ror:2 row_mask:0xf bank_mask:0xf
v_med3_u32 v42, v9, v10, v107
v_med3_u32 v46, v13, v14, v111
v_max_u32_dpp v112, v112, v112 row_ror:1 row_mask:0xf bank_mask:0xf
v_max_u32_dpp v114, v114, v114 row_ror:1 row_mask:0xf bank_mask:0xf
v_cmp_eq_u32 vcc, v112, v40
v_cmp_eq_u32 s[66:67], v114, v44
    s_nop 0
v_cndmask_b32 v40, v40, v41, vcc
v_cndmask_b32 v44, v44, v45, s[66:67]
v_cndmask_b32 v41, v41, v42, vcc
v_cndmask_b32 v45, v45, v46, s[66:67]
v_max_u32_dpp v113, v40, v40 row_ror:8 row_mask:0xf bank_mask:0xf
v_max_u32_dpp v115, v44, v44 row_ror:8 row_mask:0xf bank_mask:0xf
    s_nop 0
v_max_u32_dpp v113, v113, v113 row_ror:4 row_mask:0xf bank_mask:0xf
v_max_u32_dpp v115, v115, v115 row_ror:4 row_mask:0xf bank_mask:0xf
    s_nop 0
v_max_u32_dpp v113, v113, v113 row_ror:2 row_mask:0xf bank_mask:0xf
v_max_u32_dpp v115, v115, v115 row_ror:2 row_mask:0xf bank_mask:0xf
    s_nop 0
v_max_u32_dpp v113, v113, v113 row_ror:1 row_mask:0xf bank_mask:0xf
v_max_u32_dpp v115, v115, v115 row_ror:1 row_mask:0xf bank_mask:0xf
s_mov_b32 exec_lo, 0x00010001
s_mov_b32 exec_hi, 0x00010001
ds_write_b64 v5, v[112:113] offset:256
ds_write_b64 v5, v[114:115] offset:384
s_mov_b64 exec, 1
ds_add_u32 v99, v100 offset:560
s_mov_b64 exec, -1
L_cand_bar:
s_mov_b32 s74, 0
L_cmeet:
ds_read_b32 v98, v99 offset:560
s_add_u32 s74, s74, 1
s_waitcnt lgkmcnt(0)
v_readfirstlane_b32 s51, v98
s_cmp_ge_u32 s51, 4
s_cbranch_scc1 L_cmeet_ok
s_cmp_lt_u32 s74, 480000
s_cbranch_scc1 L_cmeet
L_cmeet_ok:
ds_read_b32 v4, v6 offset:256
ds_read_b128 v[8:11], v7 offset:256
ds_read_b128 v[12:15], v7 offset:272
ds_read_b128 v[16:19], v7 offset:288
ds_read_b128 v[20:23], v7 offset:304
v_cmp_eq_u32 vcc, v113, v40
v_cmp_eq_u32 s[66:67], v115, v44
    s_nop 0
v_cndmask_b32 v60, v40, v41, vcc
v_cndmask_b32 v61, v44, v45, s[66:67]
v_mov_b32 v5, 0
v_lshlrev_b32 v7, 4, v1
s_waitcnt lgkmcnt(3)
v_cmp_gt_u32 s[66:67], v8, v4
v_cmp_gt_u32 s[68:69], v9, v4
v_cmp_gt_u32 s[70:71], v10, v4
v_cmp_gt_u32 s[72:73], v11, v4
v_addc_co_u32 v5, vcc, v5, 0, s[66:67]
v_addc_co_u32 v5, vcc, v5, 0, s[68:69]
v_addc_co_u32 v5, vcc, v5, 0, s[70:71]
v_addc_co_u32 v5, vcc, v5, 0, s[72:73]
s_waitcnt lgkmcnt(2)
v_cmp_gt_u32 s[66:67], v12, v4
v_cmp_gt_u32 s[68:69], v13, v4
v_cmp_gt_u32 s[70:71], v14, v4
v_cmp_gt_u32 s[72:73], v15, v4
v_addc_co_u32 v5, vcc, v5, 0, s[66:67]
v_addc_co_u32 v5, vcc, v5, 0, s[68:69]
v_addc_co_u32 v5, vcc, v5, 0, s[70:71]
v_addc_co_u32 v5, vcc, v5, 0, s[72:73]
s_waitcnt lgkmcnt(1)
v_cmp_gt_u32 s[66:67], v16, v4
v_cmp_gt_u32 s[68:69], v17, v4
v_cmp_gt_u32 s[70:71], v18, v4
v_cmp_gt_u32 s[72:73], v19, v4
v_addc_co_u32 v5, vcc, v5, 0, s[66:67]
v_addc_co_u32 v5, vcc, v5, 0, s[68:69]
v_addc_co_u32 v5, vcc, v5, 0, s[70:71]
v_addc_co_u32 v5, vcc, v5, 0, s[72:73]
s_waitcnt lgkmcnt(0)
v_cmp_gt_u32 s[66:67], v20, v4
v_cmp_gt_u32 s[68:69], v21, v4
v_cmp_gt_u32 s[70:71], v22, v4
v_cmp_gt_u32 s[72:73], v23, v4
v_addc_co_u32 v5, vcc, v5, 0, s[66:67]
v_addc_co_u32 v5, vcc, v5, 0, s[68:69]
v_addc_co_u32 v5, vcc, v5, 0, s[70:71]
v_addc_co_u32 v5, vcc, v5, 0, s[72:73]
v_not_b32 v8, v4
v_and_b32 v8, 2047, v8
v_add_u32_dpp v5, v5, v5 quad_perm:[1,0,3,2] row_mask:0xf bank_mask:0xf
v_lshlrev_b32 v8, 10, v8
v_mov_b32 v10, 2560
v_add_u32_dpp v5, v5, v5 quad_perm:[2,3,0,1] row_mask:0xf bank_mask:0xf
s_mov_b32 s51, 1056
v_mad_u32_u24 v9, v5, s51, v10
v_cmp_gt_u32 vcc, 8, v5
s_and_b32 s52, vcc_lo, 0x11111111
s_and_b32 s53, vcc_hi, 0x11111111
v_lshlrev_b32 v6, 2, v5
s_cmp_eq_u64 s[52:53], 0
s_cbranch_scc1 L_nowin
s_mov_b64 s[68:69], s[52:53]
L_gloop:
s_ff1_i32_b64 s48, s[68:69]
s_bitset0_b64 s[68:69], s48
v_readlane_b32 s49, v8, s48
v_readlane_b32 s50, v9, s48
s_cmp_lg_u64 s[68:69], 0
s_mov_b32 m0, s50
s_nop 1
buffer_load_dwordx4 v7, s[8:11], s49 offen lds
s_cbranch_scc1 L_gloop
s_mov_b64 exec, s[52:53]
v_not_b32 v16, v4
v_and_b32 v17, 127, v16
v_lshlrev_b32 v17, 7, v17
v_bfe_u32 v18, v16, 10, 1
v_bfe_u32 v16, v16, 7, 3
v_lshl_add_u32 v17, v18, 3, v17
v_lshl_add_u32 v16, v16, 4, v17
s_mov_b32 s51, 65536
buffer_load_dwordx2 v[18:19], v16, s[12:15], s51 offen sc1
s_mov_b64 exec, s[52:53]
ds_write_b32 v6, v4 offset:512
s_mov_b64 exec, -1
L_nowin:
v_lshlrev_b32 v22, 13, v2
v_lshl_add_u32 v22, v3, 3, v22
v_add_u32 v23, 4096, v22
s_lshl_b32 s54, s42, 15
s_lshl_b32 s55, s3, 7
s_add_u32 s54, s54, s55
buffer_load_dwordx2 v[40:41], v22, s[32:35], s54 offen offset:0
buffer_load_dwordx2 v[42:43], v22, s[32:35], s54 offen offset:1024
buffer_load_dwordx2 v[44:45], v22, s[32:35], s54 offen offset:2048
buffer_load_dwordx2 v[46:47], v22, s[32:35], s54 offen offset:3072
buffer_load_dwordx2 v[48:49], v23, s[32:35], s54 offen offset:0
buffer_load_dwordx2 v[50:51], v23, s[32:35], s54 offen offset:1024
buffer_load_dwordx2 v[52:53], v23, s[32:35], s54 offen offset:2048
buffer_load_dwordx2 v[54:55], v23, s[32:35], s54 offen offset:3072
v_lshlrev_b32 v7, 4, v3
ds_read_b128 v[8:11], v7 offset:256
v_mov_b32 v5, 0
v_max_u32_dpp v62, v60, v60 row_ror:8 row_mask:0xf bank_mask:0xf
v_max_u32_dpp v63, v61, v61 row_ror:8 row_mask:0xf bank_mask:0xf
    s_nop 0
v_max_u32_dpp v62, v62, v62 row_ror:4 row_mask:0xf bank_mask:0xf
v_max_u32_dpp v63, v63, v63 row_ror:4 row_mask:0xf bank_mask:0xf
    s_nop 0
v_max_u32_dpp v62, v62, v62 row_ror:2 row_mask:0xf bank_mask:0xf
v_max_u32_dpp v63, v63, v63 row_ror:2 row_mask:0xf bank_mask:0xf
    s_nop 0
v_max_u32_dpp v62, v62, v62 row_ror:1 row_mask:0xf bank_mask:0xf
v_max_u32_dpp v63, v63, v63 row_ror:1 row_mask:0xf bank_mask:0xf
v_max_u32 v62, v62, v63
s_waitcnt lgkmcnt(0)
v_cmp_gt_u32 s[66:67], v8, v62
v_cmp_gt_u32 s[68:69], v9, v62
v_cmp_gt_u32 s[70:71], v10, v62
v_cmp_gt_u32 s[72:73], v11, v62
v_addc_co_u32 v5, vcc, v5, 0, s[66:67]
v_addc_co_u32 v5, vcc, v5, 0, s[68:69]
v_addc_co_u32 v5, vcc, v5, 0, s[70:71]
v_addc_co_u32 v5, vcc, v5, 0, s[72:73]
    s_nop 1
v_add_u32_dpp v5, v5, v5 row_ror:8 row_mask:0xf bank_mask:0xf
    s_nop 1
v_add_u32_dpp v5, v5, v5 row_ror:4 row_mask:0xf bank_mask:0xf
    s_nop 1
v_add_u32_dpp v5, v5, v5 row_ror:2 row_mask:0xf bank_mask:0xf
    s_nop 1
v_add_u32_dpp v5, v5, v5 row_ror:1 row_mask:0xf bank_mask:0xf
v_cmp_gt_u32 vcc, 8, v5
s_cbranch_vccnz L_trip
L_guard_ok:
v_mov_b32 v17, v6
v_and_b32 v4, 7, v1
v_lshlrev_b32 v5, 2, v4
v_mov_b32 v7, 0
v_mul_u32_u24 v6, 1056, v4
v_lshl_add_u32 v6, v2, 4, v6
s_lshl_b32 s56, s3, 8
s_lshl_b32 s57, s42, 14
s_add_u32 s56, s56, s57
s_add_u32 s56, s56, 4194304
s_add_u32 s57, s56, 128
s_mov_b32 s58, 0x07060500
s_mov_b32 s59, 0x07060501
s_mov_b32 s60, 0x07060502
s_mov_b32 s61, 0x07060503
s_cmp_eq_u64 s[52:53], 0
s_cbranch_scc1 L_nostat
s_mov_b64 exec, s[52:53]
s_mov_b32 s74, 0
s_waitcnt vmcnt(8)
s_branch L_gst1
L_gst:
s_waitcnt vmcnt(0)
L_gst1:
v_cmp_ne_u32 vcc, s36, v19
s_cbranch_vccz L_gst_ok
s_add_u32 s74, s74, 1
s_cmp_ge_u32 s74, 60000
s_cbranch_scc1 L_gst_ok
buffer_load_dwordx2 v[18:19], v16, s[12:15], s51 offen sc1
s_branch L_gst
L_gst_ok:
ds_write_b32 v17, v18 offset:576
s_mov_b64 exec, -1
s_branch L_nostat
L_wteam:
v_mov_b32 v10, 1
s_waitcnt vmcnt(4)
s_mov_b64 exec, 1
ds_add_u32 v7, v10 offset:564
s_mov_b64 exec, -1
s_mov_b32 s54, 0x05040100
s_mov_b32 s55, 0x07060302
v_perm_b32 v24, v110, v108, s54
v_perm_b32 v25, v114, v112, s54
v_perm_b32 v26, v118, v116, s54
v_perm_b32 v27, v122, v120, s54
v_perm_b32 v28, v110, v108, s55
v_perm_b32 v29, v114, v112, s55
v_perm_b32 v30, v118, v116, s55
v_perm_b32 v31, v122, v120, s55
v_perm_b32 v32, v111, v109, s54
v_perm_b32 v33, v115, v113, s54
v_perm_b32 v34, v119, v117, s54
v_perm_b32 v35, v123, v121, s54
v_perm_b32 v36, v111, v109, s55
v_perm_b32 v37, v115, v113, s55
v_perm_b32 v38, v119, v117, s55
v_perm_b32 v39, v123, v121, s55
s_mov_b32 s74, 0
L_m1:
ds_read_b32 v9, v7 offset:564
s_add_u32 s74, s74, 1
s_waitcnt lgkmcnt(0)
v_readfirstlane_b32 s48, v9
s_cmp_ge_u32 s48, 4
s_cbranch_scc1 L_m1_ok
s_cmp_lt_u32 s74, 480000
s_cbranch_scc1 L_m1
L_m1_ok:
ds_read_b64_tr_b16 v[40:41], v8 offset:0
ds_read_b64_tr_b16 v[42:43], v8 offset:256
ds_read_b64_tr_b16 v[44:45], v8 offset:2048
ds_read_b64_tr_b16 v[46:47], v8 offset:2304
ds_read_b64_tr_b16 v[48:49], v8 offset:4096
ds_read_b64_tr_b16 v[50:51], v8 offset:4352
ds_read_b64_tr_b16 v[52:53], v8 offset:6144
ds_read_b64_tr_b16 v[54:55], v8 offset:6400
ds_read_b64_tr_b16 v[56:57], v8 offset:8192
ds_read_b64_tr_b16 v[58:59], v8 offset:8448
ds_read_b64_tr_b16 v[60:61], v8 offset:10240
ds_read_b64_tr_b16 v[62:63], v8 offset:10496
ds_read_b64_tr_b16 v[64:65], v8 offset:12288
ds_read_b64_tr_b16 v[66:67], v8 offset:12544
s_waitcnt lgkmcnt(12)
v_mfma_f32_16x16x32_bf16 v[104:107], v[40:43], v[12:15], 0
ds_read_b64_tr_b16 v[68:69], v8 offset:14336
ds_read_b64_tr_b16 v[70:71], v8 offset:14592
s_waitcnt lgkmcnt(12)
v_mfma_f32_16x16x32_bf16 v[104:107], v[44:47], v[12:15], v[104:107]
ds_read_b64_tr_b16 v[72:73], v8 offset:16384
ds_read_b64_tr_b16 v[74:75], v8 offset:16640
s_waitcnt lgkmcnt(12)
v_mfma_f32_16x16x32_bf16 v[104:107], v[48:51], v[12:15], v[104:107]
ds_read_b64_tr_b16 v[80:81], v8 offset:20480
ds_read_b64_tr_b16 v[82:83], v8 offset:20736
s_waitcnt lgkmcnt(12)
v_mfma_f32_16x16x32_bf16 v[104:107], v[52:55], v[12:15], v[104:107]
ds_read_b64_tr_b16 v[88:89], v8 offset:24576
ds_read_b64_tr_b16 v[90:91], v8 offset:24832
s_waitcnt lgkmcnt(12)
v_mfma_f32_16x16x32_bf16 v[104:107], v[56:59], v[12:15], v[104:107]
ds_read_b64_tr_b16 v[96:97], v8 offset:28672
ds_read_b64_tr_b16 v[98:99], v8 offset:28928
s_waitcnt lgkmcnt(12)
v_mfma_f32_16x16x32_bf16 v[104:107], v[60:63], v[12:15], v[104:107]
s_waitcnt lgkmcnt(10)
v_mfma_f32_16x16x32_bf16 v[104:107], v[64:67], v[12:15], v[104:107]
s_waitcnt lgkmcnt(8)
v_mfma_f32_16x16x32_bf16 v[104:107], v[68:71], v[12:15], v[104:107]
s_waitcnt lgkmcnt(6)
v_mfma_f32_16x16x32_bf16 v[104:107], v[72:75], v[12:15], v[104:107]
s_waitcnt lgkmcnt(4)
v_mfma_f32_16x16x32_bf16 v[104:107], v[80:83], v[12:15], v[104:107]
s_waitcnt lgkmcnt(2)
v_mfma_f32_16x16x32_bf16 v[104:107], v[88:91], v[12:15], v[104:107]
s_waitcnt lgkmcnt(0)
v_mfma_f32_16x16x32_bf16 v[104:107], v[96:99], v[12:15], v[104:107]
s_waitcnt vmcnt(0)
s_mov_b64 exec, 1
ds_add_u32 v7, v10 offset:548
s_mov_b64 exec, -1
s_mov_b32 s74, 0
L_m2:
ds_read_b32 v9, v7 offset:548
s_add_u32 s74, s74, 1
s_waitcnt lgkmcnt(0)
v_readfirstlane_b32 s48, v9
s_cmp_ge_u32 s48, 4
s_cbranch_scc1 L_m2_ok
s_cmp_lt_u32 s74, 480000
s_cbranch_scc1 L_m2
L_m2_ok:
ds_read_b64_tr_b16 v[76:77], v8 offset:18432
ds_read_b64_tr_b16 v[78:79], v8 offset:18688
ds_read_b64_tr_b16 v[84:85], v8 offset:22528
ds_read_b64_tr_b16 v[86:87], v8 offset:22784
ds_read_b64_tr_b16 v[92:93], v8 offset:26624
ds_read_b64_tr_b16 v[94:95], v8 offset:26880
ds_read_b64_tr_b16 v[100:101], v8 offset:30720
ds_read_b64_tr_b16 v[102:103], v8 offset:30976
s_waitcnt lgkmcnt(6)
v_mfma_f32_16x16x32_bf16 v[104:107], v[76:79], v[12:15], v[104:107]
s_waitcnt lgkmcnt(4)
v_mfma_f32_16x16x32_bf16 v[104:107], v[84:87], v[12:15], v[104:107]
s_waitcnt lgkmcnt(2)
v_mfma_f32_16x16x32_bf16 v[104:107], v[92:95], v[12:15], v[104:107]
s_waitcnt lgkmcnt(0)
v_mfma_f32_16x16x32_bf16 v[104:107], v[100:103], v[12:15], v[104:107]
s_lshl_b32 s48, s2, 7
s_add_u32 s48, s48, 155648
s_lshl_b32 s49, s42, 7
s_add_u32 s49, s49, 131072
s_cmp_eq_u32 s3, 5
s_cselect_b32 s48, s49, s48
s_cbranch_scc1 L_go1
s_cmp_lg_u32 s3, 4
s_cbranch_scc1 L_nogo
s_cmp_ge_u32 s2, 144
s_cbranch_scc1 L_nogo
L_go1:
v_mov_b32 v8, s36
s_mov_b64 exec, 1
buffer_store_dword v8, off, s[12:15], s48 sc1
s_waitcnt vmcnt(63)
s_branch L_go2
L_nogo:
s_waitcnt vmcnt(62)
L_go2:
s_mov_b64 exec, -1
L_nostat:
s_cmp_ge_u32 s3, 4
s_waitcnt lgkmcnt(0)
s_barrier
s_cbranch_scc1 L_gu
L_selp:
ds_read_b32 v8, v7 offset:544
ds_read_b32 v20, v5 offset:512
s_waitcnt lgkmcnt(1)
v_readfirstlane_b32 s48, v8
s_cmp_lg_u32 s48, 0
s_cbranch_scc1 L_rare
L_sel_done:
s_cmp_lg_u32 s3, 0
s_cbranch_scc1 L_noidx
s_cmp_ge_u32 s2, 144
s_cbranch_scc1 L_noidx
s_waitcnt lgkmcnt(0)
v_mov_b32 v21, s36
v_lshlrev_b32 v5, 3, v1
s_lshl_b32 s48, s2, 7
s_add_u32 s48, s48, 147456
s_mov_b64 exec, 0xff
buffer_store_dwordx2 v[20:21], v5, s[12:15], s48 offen sc1
s_mov_b64 exec, -1
s_waitcnt vmcnt(1)
s_branch L_idx2
L_noidx:
s_waitcnt vmcnt(0)
L_idx2:
s_mov_b32 s54, 0x05040100
s_mov_b32 s55, 0x07060302
v_perm_b32 v24, v42, v40, s54
v_perm_b32 v25, v46, v44, s54
v_perm_b32 v26, v50, v48, s54
v_perm_b32 v27, v54, v52, s54
v_perm_b32 v28, v42, v40, s55
v_perm_b32 v29, v46, v44, s55
v_perm_b32 v30, v50, v48, s55
v_perm_b32 v31, v54, v52, s55
v_perm_b32 v32, v43, v41, s54
v_perm_b32 v33, v47, v45, s54
v_perm_b32 v34, v51, v49, s54
v_perm_b32 v35, v55, v53, s54
v_perm_b32 v36, v43, v41, s55
v_perm_b32 v37, v47, v45, s55
v_perm_b32 v38, v51, v49, s55
v_perm_b32 v39, v55, v53, s55
v_lshlrev_b32 v18, 6, v4
v_lshl_add_u32 v18, v2, 4, v18
v_lshlrev_b32 v19, 11, v4
v_lshrrev_b32 v17, 1, v2
v_lshl_add_u32 v19, v17, 5, v19
v_and_b32 v17, 1, v2
v_lshl_add_u32 v19, v17, 6, v19
v_and_b32 v17, 8, v1
v_lshl_add_u32 v19, v17, 1, v19
v_cmp_ne_u32 vcc, 0, v17
v_mov_b32 v16, s36
s_nop 0
s_branch L_nogu
L_gu:
ds_read_b32 v22, v7 offset:544
ds_read_b32 v21, v5 offset:576
ds_read_b128 v[8:11], v6 offset:2560
ds_read_b128 v[12:15], v6 offset:2624
ds_read_b128 v[16:19], v6 offset:2688
ds_read_b128 v[108:111], v6 offset:2752
ds_read_b128 v[112:115], v6 offset:2816
ds_read_b128 v[116:119], v6 offset:2880
ds_read_b128 v[120:123], v6 offset:2944
s_waitcnt lgkmcnt(8)
v_readfirstlane_b32 s48, v22
s_cmp_lg_u32 s48, 0
s_cbranch_scc1 L_rare
L_gu2:
s_lshl_b32 s48, s3, 4
s_sub_u32 s48, s48, 64
s_waitcnt lgkmcnt(6)
v_mfma_f32_16x16x32_bf16 v[124:127], v[40:43], v[8:11], 0
ds_read_b128 v[8:11], v6 offset:3008
s_waitcnt lgkmcnt(6)
v_mfma_f32_16x16x32_bf16 v[124:127], v[44:47], v[12:15], v[124:127]
ds_read_b128 v[12:15], v6 offset:3072
v_and_b32 v23, s46, v21
v_lshlrev_b32 v22, 16, v21
v_rcp_f32 v23, v23
s_waitcnt lgkmcnt(6)
v_mfma_f32_16x16x32_bf16 v[124:127], v[48:51], v[16:19], v[124:127]
ds_read_b128 v[16:19], v6 offset:3136
s_waitcnt lgkmcnt(6)
v_mfma_f32_16x16x32_bf16 v[124:127], v[52:55], v[108:111], v[124:127]
ds_read_b128 v[108:111], v6 offset:3200
v_mul_f32 v22, -v22, v23
s_waitcnt lgkmcnt(6)
v_mfma_f32_16x16x32_bf16 v[124:127], v[56:59], v[112:115], v[124:127]
ds_read_b128 v[112:115], v6 offset:3264
v_mul_f32 v104, v22, v104
v_mul_f32 v105, v22, v105
v_mul_f32 v106, v22, v106
v_mul_f32 v107, v22, v107
s_waitcnt lgkmcnt(6)
v_mfma_f32_16x16x32_bf16 v[124:127], v[60:63], v[116:119], v[124:127]
ds_read_b128 v[116:119], v6 offset:3328
s_waitcnt lgkmcnt(6)
v_mfma_f32_16x16x32_bf16 v[124:127], v[64:67], v[120:123], v[124:127]
ds_read_b128 v[120:123], v6 offset:3392
s_waitcnt lgkmcnt(6)
v_mfma_f32_16x16x32_bf16 v[124:127], v[68:71], v[8:11], v[124:127]
ds_read_b128 v[8:11], v6 offset:3456
s_waitcnt lgkmcnt(6)
v_mfma_f32_16x16x32_bf16 v[124:127], v[72:75], v[12:15], v[124:127]
ds_read_b128 v[12:15], v6 offset:3520
s_waitcnt lgkmcnt(6)
v_mfma_f32_16x16x32_bf16 v[124:127], v[76:79], v[16:19], v[124:127]
v_and_b32 v6, 1, v2
v_lshlrev_b32 v6, 3, v6
v_lshl_add_u32 v6, v4, 6, v6
s_waitcnt lgkmcnt(5)
v_mfma_f32_16x16x32_bf16 v[124:127], v[80:83], v[108:111], v[124:127]
v_lshrrev_b32 v7, 5, v1
v_lshl_add_u32 v6, v7, 2, v6
v_add_u32 v6, s48, v6
s_waitcnt lgkmcnt(4)
v_mfma_f32_16x16x32_bf16 v[124:127], v[84:87], v[112:115], v[124:127]
s_waitcnt lgkmcnt(3)
v_mfma_f32_16x16x32_bf16 v[124:127], v[88:91], v[116:119], v[124:127]
v_lshlrev_b32 v18, 6, v4
v_lshl_add_u32 v18, v2, 4, v18
v_lshlrev_b32 v19, 11, v4
v_lshrrev_b32 v17, 1, v2
s_waitcnt lgkmcnt(2)
v_mfma_f32_16x16x32_bf16 v[124:127], v[92:95], v[120:123], v[124:127]
s_waitcnt lgkmcnt(1)
v_mfma_f32_16x16x32_bf16 v[124:127], v[96:99], v[8:11], v[124:127]
s_waitcnt lgkmcnt(0)
v_mfma_f32_16x16x32_bf16 v[124:127], v[100:103], v[12:15], v[124:127]
v_lshl_add_u32 v19, v17, 5, v19
v_and_b32 v17, 1, v2
v_lshl_add_u32 v19, v17, 6, v19
v_and_b32 v17, 8, v1
v_lshl_add_u32 v19, v17, 1, v19
v_cmp_ne_u32 vcc, 0, v17
v_mov_b32 v16, s36
s_nop 0
v_fma_f32 v8, v124, v23, v104
v_fma_f32 v10, v126, v23, v106
v_fma_f32 v9, v125, v23, v105
v_fma_f32 v11, v127, v23, v107
v_permlane32_swap_b32 v8, v10
    s_nop 0
v_permlane32_swap_b32 v9, v11
v_mul_f32 v12, 0xbfb8aa3b, v8
v_mul_f32 v13, 0xbfb8aa3b, v9
v_exp_f32 v12, v12
v_exp_f32 v13, v13
v_mul_f32 v8, v8, v10
v_mul_f32 v9, v9, v11
v_add_f32 v12, 1.0, v12
v_add_f32 v13, 1.0, v13
v_rcp_f32 v12, v12
v_rcp_f32 v13, v13
s_mov_b32 exec_lo, 0x00ff00ff
v_mul_f32 v8, v8, v12
v_mul_f32 v9, v9, v13
s_mov_b32 exec_hi, 0x00ff00ff
v_cvt_pk_bf16_f32 v8, v8, v9
ds_write_b32 v6, v8 offset:768
s_mov_b64 exec, -1
L_nogu:
s_waitcnt lgkmcnt(0)
s_barrier
ds_read_b128 v[8:11], v18 offset:768
s_waitcnt lgkmcnt(0)
v_mfma_f32_16x16x32_bf16 v[40:43], v[24:27], v[8:11], 0
v_mfma_f32_16x16x32_bf16 v[44:47], v[28:31], v[8:11], 0
v_mfma_f32_16x16x32_bf16 v[48:51], v[32:35], v[8:11], 0
v_mfma_f32_16x16x32_bf16 v[52:55], v[36:39], v[8:11], 0
    s_nop 4
v_cndmask_b32 v56, v40, v41, vcc
v_cndmask_b32 v60, v42, v43, vcc
v_cndmask_b32 v57, v44, v45, vcc
v_cndmask_b32 v61, v46, v47, vcc
v_cndmask_b32 v58, v48, v49, vcc
v_cndmask_b32 v62, v50, v51, vcc
v_cndmask_b32 v59, v52, v53, vcc
v_cndmask_b32 v63, v54, v55, vcc
v_permlane32_swap_b32 v56, v60
v_permlane32_swap_b32 v57, v61
v_permlane32_swap_b32 v58, v62
v_permlane32_swap_b32 v59, v63
v_perm_b32 v56, v56, v16, s58
v_perm_b32 v57, v57, v16, s59
v_perm_b32 v58, v58, v16, s60
v_perm_b32 v59, v59, v16, s61
buffer_store_dwordx4 v[56:59], v19, s[12:15], s56 offen sc1
v_perm_b32 v60, v60, v16, s58
v_perm_b32 v61, v61, v16, s59
v_perm_b32 v62, v62, v16, s60
v_perm_b32 v63, v63, v16, s61
buffer_store_dwordx4 v[60:63], v19, s[12:15], s57 offen sc1
s_cmp_lg_u32 s3, 7
s_cbranch_scc1 L_nopf
s_lshl_b32 s48, s2, 7
s_add_u32 s48, s48, 180224
s_mov_b64 exec, 1
buffer_store_dword v16, off, s[12:15], s48 sc1
s_mov_b64 exec, -1
L_nopf:
s_branch L_fin
L_trip:
s_and_b32 s48, vcc_lo, 0x00010001
s_and_b32 s49, vcc_hi, 0x00010001
s_bcnt1_i32_b64 s50, s[48:49]
s_ff1_i32_b64 s48, s[48:49]
v_lshlrev_b32 v7, 4, v1
v_readlane_b32 s49, v62, s48
s_mov_b32 m0, 11008
s_andn2_b32 s48, 2047, s49
s_lshl_b32 s48, s48, 10
buffer_load_dwordx4 v7, s[8:11], s48 offen lds
v_mov_b32 v15, s49
v_not_b32 v56, v15
v_and_b32 v57, 127, v56
v_lshlrev_b32 v57, 7, v57
v_bfe_u32 v58, v56, 10, 1
v_bfe_u32 v56, v56, 7, 3
v_lshl_add_u32 v57, v58, 3, v57
v_lshl_add_u32 v56, v56, 4, v57
s_mov_b32 s48, 65536
s_mov_b32 s74, 0
s_mov_b64 exec, 1
buffer_load_dwordx2 v[60:61], v56, s[12:15], s48 offen sc1
ds_write_b32 v99, v15 offset:568
s_mov_b64 exec, -1
v_min_u32 v12, v62, v113
v_min_u32 v13, v62, v115
v_cmp_lt_u32 s[66:67], v104, v12
v_cmp_lt_u32 s[68:69], v105, v12
v_cmp_lt_u32 s[70:71], v106, v12
v_cmp_lt_u32 s[72:73], v107, v12
v_cndmask_b32 v104, 0, v104, s[66:67]
v_cndmask_b32 v105, 0, v105, s[68:69]
v_cndmask_b32 v106, 0, v106, s[70:71]
v_cndmask_b32 v107, 0, v107, s[72:73]
v_cmp_lt_u32 s[66:67], v108, v13
v_cmp_lt_u32 s[68:69], v109, v13
v_cmp_lt_u32 s[70:71], v110, v13
v_cmp_lt_u32 s[72:73], v111, v13
v_cndmask_b32 v108, 0, v108, s[66:67]
v_cndmask_b32 v109, 0, v109, s[68:69]
v_cndmask_b32 v110, 0, v110, s[70:71]
v_cndmask_b32 v111, 0, v111, s[72:73]
v_max3_u32 v12, v104, v105, v106
v_max3_u32 v12, v12, v107, v108
v_max3_u32 v12, v12, v109, v110
v_max_u32 v12, v12, v111
    s_nop 1
v_max_u32_dpp v13, v12, v12 row_ror:8 row_mask:0xf bank_mask:0xf
    s_nop 1
v_max_u32_dpp v13, v13, v13 row_ror:4 row_mask:0xf bank_mask:0xf
    s_nop 1
v_max_u32_dpp v13, v13, v13 row_ror:2 row_mask:0xf bank_mask:0xf
    s_nop 1
v_max_u32_dpp v13, v13, v13 row_ror:1 row_mask:0xf bank_mask:0xf
v_mov_b32 v5, 0
v_cmp_gt_u32 s[66:67], v8, v13
v_cmp_gt_u32 s[68:69], v9, v13
v_cmp_gt_u32 s[70:71], v10, v13
v_cmp_gt_u32 s[72:73], v11, v13
v_addc_co_u32 v5, vcc, v5, 0, s[66:67]
v_addc_co_u32 v5, vcc, v5, 0, s[68:69]
v_addc_co_u32 v5, vcc, v5, 0, s[70:71]
v_addc_co_u32 v5, vcc, v5, 0, s[72:73]
    s_nop 1
v_add_u32_dpp v5, v5, v5 row_ror:8 row_mask:0xf bank_mask:0xf
    s_nop 1
v_add_u32_dpp v5, v5, v5 row_ror:4 row_mask:0xf bank_mask:0xf
    s_nop 1
v_add_u32_dpp v5, v5, v5 row_ror:2 row_mask:0xf bank_mask:0xf
    s_nop 1
v_add_u32_dpp v5, v5, v5 row_ror:1 row_mask:0xf bank_mask:0xf
v_cmp_gt_u32 vcc, 8, v5
s_cmp_lg_u64 vcc, 0
s_addc_u32 s50, s50, 0
v_mov_b32 v13, s50
s_mov_b64 exec, 1
ds_add_u32 v99, v13 offset:544
L_gst3:
s_waitcnt vmcnt(0)
v_cmp_ne_u32 vcc, s36, v61
s_cbranch_vccz L_gst3_ok
s_add_u32 s74, s74, 1
s_cmp_ge_u32 s74, 60000
s_cbranch_scc1 L_gst3_ok
buffer_load_dwordx2 v[60:61], v56, s[12:15], s48 offen sc1
s_branch L_gst3
L_gst3_ok:
ds_write_b32 v99, v60 offset:572
s_mov_b64 exec, -1
s_branch L_guard_ok
L_rare:
s_cmp_lg_u32 s48, 1
s_cbranch_scc1 L_slow
s_waitcnt lgkmcnt(0)
ds_read_b64 v[22:23], v7 offset:568
v_cmp_eq_u32 vcc, 7, v4
v_add_u32 v8, 1056, v6
s_cmp_lt_u32 s3, 4
s_waitcnt lgkmcnt(0)
v_cndmask_b32 v20, v20, v22, vcc
v_or_b32 v20, 0x8000, v20
s_cbranch_scc1 L_sel_done
v_cndmask_b32 v21, v21, v23, vcc
v_cndmask_b32 v6, v6, v8, vcc
ds_read_b128 v[8:11], v6 offset:2560
ds_read_b128 v[12:15], v6 offset:2624
ds_read_b128 v[16:19], v6 offset:2688
ds_read_b128 v[108:111], v6 offset:2752
ds_read_b128 v[112:115], v6 offset:2816
ds_read_b128 v[116:119], v6 offset:2880
ds_read_b128 v[120:123], v6 offset:2944
s_branch L_gu2
L_slow:
s_waitcnt lgkmcnt(0)
ds_read_b32 v20, v5 offset:512
v_mov_b32 v22, 0
v_lshlrev_b32 v7, 2, v1
ds_write_b32 v7, v22 offset:256
ds_write_b32 v22, v22 offset:552
v_lshrrev_b32 v16, 2, v0
v_and_b32 v17, 3, v0
v_lshlrev_b32 v6, 7, v16
v_lshl_add_u32 v6, v17, 4, v6
v_lshl_add_u32 v16, v17, 8, v16
v_sub_u32 v16, 2047, v16
v_subrev_u32 v17, 1024, v16
v_subrev_u32 v18, 128, v16
v_subrev_u32 v19, 1152, v16
s_lshl_b32 s48, s82, 14
s_add_u32 s48, s48, 524288
buffer_load_dwordx4 v[8:11], v6, s[12:15], s48 offen sc1
s_waitcnt vmcnt(0) lgkmcnt(0)
v_lshl_or_b32 v12, v8, 16, v16
v_and_or_b32 v13, v8, s46, v17
v_lshl_or_b32 v14, v10, 16, v18
v_and_or_b32 v15, v10, s46, v19
v_readlane_b32 s53, v20, 7
s_barrier
    s_nop 0
v_cmp_le_u32 s[66:67], s53, v12
v_cmp_le_u32 s[68:69], s53, v13
v_cmp_le_u32 s[70:71], s53, v14
v_cmp_le_u32 s[72:73], s53, v15
s_bcnt1_i32_b64 s48, s[66:67]
s_bcnt1_i32_b64 s49, s[68:69]
s_bcnt1_i32_b64 s50, s[70:71]
s_bcnt1_i32_b64 s51, s[72:73]
s_add_u32 s49, s49, s48
s_add_u32 s50, s50, s49
s_add_u32 s51, s51, s50
v_mov_b32 v8, s51
s_mov_b64 exec, 1
ds_add_rtn_u32 v8, v22, v8 offset:552
s_mov_b64 exec, -1
s_waitcnt lgkmcnt(0)
v_readfirstlane_b32 s52, v8
v_mbcnt_lo_u32_b32 v8, s66, 0
v_mbcnt_hi_u32_b32 v8, s67, v8
v_add_u32 v8, s52, v8
v_cmp_gt_u32 vcc, 64, v8
v_lshlrev_b32 v8, 2, v8
s_and_b64 exec, vcc, s[66:67]
s_cbranch_execz L_app0
ds_write_b32 v8, v12 offset:256
L_app0:
s_mov_b64 exec, -1
v_mbcnt_lo_u32_b32 v8, s68, 0
v_mbcnt_hi_u32_b32 v8, s69, v8
v_add_u32 v8, s52, v8
v_add_u32 v8, s48, v8
v_cmp_gt_u32 vcc, 64, v8
v_lshlrev_b32 v8, 2, v8
s_and_b64 exec, vcc, s[68:69]
s_cbranch_execz L_app1
ds_write_b32 v8, v13 offset:256
L_app1:
s_mov_b64 exec, -1
v_mbcnt_lo_u32_b32 v8, s70, 0
v_mbcnt_hi_u32_b32 v8, s71, v8
v_add_u32 v8, s52, v8
v_add_u32 v8, s49, v8
v_cmp_gt_u32 vcc, 64, v8
v_lshlrev_b32 v8, 2, v8
s_and_b64 exec, vcc, s[70:71]
s_cbranch_execz L_app2
ds_write_b32 v8, v14 offset:256
L_app2:
s_mov_b64 exec, -1
v_mbcnt_lo_u32_b32 v8, s72, 0
v_mbcnt_hi_u32_b32 v8, s73, v8
v_add_u32 v8, s52, v8
v_add_u32 v8, s50, v8
v_cmp_gt_u32 vcc, 64, v8
v_lshlrev_b32 v8, 2, v8
s_and_b64 exec, vcc, s[72:73]
s_cbranch_execz L_app3
ds_write_b32 v8, v15 offset:256
L_app3:
s_mov_b64 exec, -1
s_lshl_b32 s49, s3, 5
v_lshrrev_b32 v6, 3, v1
v_lshl_add_u32 v6, v6, 2, s49
v_lshlrev_b32 v7, 5, v4
s_waitcnt lgkmcnt(0)
s_barrier
ds_read_b32 v23, v22 offset:552
ds_read_b32 v6, v6 offset:256
ds_read_b128 v[8:11], v7 offset:256
ds_read_b128 v[16:19], v7 offset:272
s_waitcnt lgkmcnt(0)
v_readfirstlane_b32 s48, v23
s_cmp_gt_u32 s48, 64
s_cbranch_scc1 L_vslow
v_mov_b32 v7, 0
v_cmp_gt_u32 s[66:67], v8, v6
v_cmp_gt_u32 s[68:69], v9, v6
v_cmp_gt_u32 s[70:71], v10, v6
v_cmp_gt_u32 s[72:73], v11, v6
v_addc_co_u32 v7, vcc, v7, 0, s[66:67]
v_addc_co_u32 v7, vcc, v7, 0, s[68:69]
v_addc_co_u32 v7, vcc, v7, 0, s[70:71]
v_addc_co_u32 v7, vcc, v7, 0, s[72:73]
v_cmp_gt_u32 s[66:67], v16, v6
v_cmp_gt_u32 s[68:69], v17, v6
v_cmp_gt_u32 s[70:71], v18, v6
v_cmp_gt_u32 s[72:73], v19, v6
v_addc_co_u32 v7, vcc, v7, 0, s[66:67]
v_addc_co_u32 v7, vcc, v7, 0, s[68:69]
v_addc_co_u32 v7, vcc, v7, 0, s[70:71]
v_addc_co_u32 v7, vcc, v7, 0, s[72:73]
    s_nop 1
v_add_u32_dpp v7, v7, v7 quad_perm:[1,0,3,2] row_mask:0xf bank_mask:0xf
    s_nop 1
v_add_u32_dpp v7, v7, v7 quad_perm:[2,3,0,1] row_mask:0xf bank_mask:0xf
    s_nop 1
v_add_u32_dpp v7, v7, v7 row_half_mirror row_mask:0xf bank_mask:0xf
v_cmp_gt_u32 vcc, 8, v7
v_lshlrev_b32 v7, 2, v7
s_and_b64 exec, vcc, exec
s_cbranch_execz L_mnw
ds_write_b32 v7, v6 offset:512
L_mnw:
s_mov_b64 exec, -1
s_waitcnt lgkmcnt(0)
s_barrier
ds_read_b32 v20, v5 offset:512
s_waitcnt lgkmcnt(0)
s_branch L_regather
L_vslow:
s_mov_b32 s52, 0
s_lshl_b32 s53, s3, 2
v_mov_b32 v7, s53
L_sloop:
v_max_u32 v8, v12, v13
v_max3_u32 v8, v8, v14, v15
    s_nop 1
v_max_u32_dpp v9, v8, v8 row_ror:8 row_mask:0xf bank_mask:0xf
    s_nop 1
v_max_u32_dpp v9, v9, v9 row_ror:4 row_mask:0xf bank_mask:0xf
    s_nop 1
v_max_u32_dpp v9, v9, v9 row_ror:2 row_mask:0xf bank_mask:0xf
    s_nop 1
v_max_u32_dpp v9, v9, v9 row_ror:1 row_mask:0xf bank_mask:0xf
    s_nop 0
v_readlane_b32 s48, v9, 0
v_readlane_b32 s49, v9, 16
v_readlane_b32 s50, v9, 32
v_readlane_b32 s51, v9, 48
s_max_u32 s48, s48, s49
s_max_u32 s50, s50, s51
s_max_u32 s48, s48, s50
v_mov_b32 v8, s48
s_barrier
ds_write_b32 v7, v8 offset:640
s_waitcnt lgkmcnt(0)
s_barrier
ds_read_b32 v8, v5 offset:640
s_waitcnt lgkmcnt(0)
v_max_u32_dpp v9, v8, v8 row_ror:8 row_mask:0xf bank_mask:0xf
    s_nop 1
v_max_u32_dpp v9, v9, v9 row_ror:4 row_mask:0xf bank_mask:0xf
    s_nop 1
v_max_u32_dpp v9, v9, v9 row_ror:2 row_mask:0xf bank_mask:0xf
    s_nop 1
v_max_u32_dpp v9, v9, v9 row_ror:1 row_mask:0xf bank_mask:0xf
v_cmp_eq_u32 vcc, v9, v12
    s_nop 1
v_cndmask_b32 v12, v12, 0, vcc
v_cmp_eq_u32 vcc, v9, v13
    s_nop 1
v_cndmask_b32 v13, v13, 0, vcc
v_cmp_eq_u32 vcc, v9, v14
    s_nop 1
v_cndmask_b32 v14, v14, 0, vcc
v_cmp_eq_u32 vcc, v9, v15
    s_nop 1
v_cndmask_b32 v15, v15, 0, vcc
v_cmp_eq_u32 vcc, s52, v4
    s_nop 1
v_cndmask_b32 v20, v20, v9, vcc
s_add_u32 s52, s52, 1
s_cmp_lt_u32 s52, 8
s_cbranch_scc1 L_sloop
L_regather:
v_readlane_b32 s49, v20, s3
v_lshlrev_b32 v7, 4, v1
s_andn2_b32 s49, 2047, s49
s_lshl_b32 s49, s49, 10
s_mul_i32 s50, s3, 1056
s_add_u32 m0, s50, 2560
    s_nop 0
buffer_load_dwordx4 v7, s[8:11], s49 offen lds
v_not_b32 v8, v20
v_and_b32 v9, 127, v8
v_lshlrev_b32 v9, 7, v9
v_bfe_u32 v10, v8, 10, 1
v_bfe_u32 v8, v8, 7, 3
v_lshl_add_u32 v9, v10, 3, v9
v_lshl_add_u32 v8, v8, 4, v9
s_mov_b32 s48, 65536
s_mov_b32 s74, 0
L_gst2:
buffer_load_dwordx2 v[10:11], v8, s[12:15], s48 offen sc1
s_add_u32 s74, s74, 1
s_waitcnt vmcnt(0)
v_cmp_ne_u32 vcc, s36, v11
s_cbranch_vccz L_gst2_ok
s_cmp_lt_u32 s74, 60000
s_cbranch_scc1 L_gst2
L_gst2_ok:
v_mov_b32 v21, v10
s_barrier
s_cmp_lt_u32 s3, 4
s_cbranch_scc1 L_sel_done
v_mul_u32_u24 v6, 1056, v4
v_lshl_add_u32 v6, v2, 4, v6
ds_read_b128 v[8:11], v6 offset:2560
ds_read_b128 v[12:15], v6 offset:2624
ds_read_b128 v[16:19], v6 offset:2688
ds_read_b128 v[108:111], v6 offset:2752
ds_read_b128 v[112:115], v6 offset:2816
ds_read_b128 v[116:119], v6 offset:2880
ds_read_b128 v[120:123], v6 offset:2944
s_branch L_gu2
L_code_end:
.section .rodata,"a"
.p2align 6
.amdhsa_kernel parallel_sum__spectral_fnet__moe_arch_mod__prompt_kernel
  .amdhsa_next_free_vgpr 128
  .amdhsa_next_free_sgpr 102
  .amdhsa_accum_offset 128
  .amdhsa_group_segment_fixed_size 0
  .amdhsa_kernarg_size 104
  .amdhsa_user_sgpr_count 2
  .amdhsa_user_sgpr_kernarg_segment_ptr 1
  .amdhsa_system_sgpr_workgroup_id_x 1
.end_amdhsa_kernel
```
